```python
import torch

def _softmax(x, axis=-1):
    return torch.softmax(x, dim=axis)
def _gelu(x):
    return torch.nn.functional.gelu(x, approximate="tanh")
def _silu(x):
    return torch.nn.functional.silu(x)
def _sigmoid(x):
    return torch.sigmoid(x)
def _layernorm(x, axis=-1, eps=1e-5):
    m = x.mean(dim=axis, keepdim=True)
    v = x.var(dim=axis, keepdim=True, unbiased=False)
    return (x - m) / torch.sqrt(v + eps)
def _scatter_add(tgt, idx, src, axis=0):
    return tgt.clone().index_add_(axis, idx, src)
def _segment_sum(src, seg, n):
    out = torch.zeros((n,) + src.shape[1:], dtype=src.dtype)
    return out.index_add_(0, seg, src)
def _pad(x, pw):
    flat = tuple(v for pair in reversed(pw) for v in pair)
    return torch.nn.functional.pad(x, flat)

kernel_name = 'sequential_preLN__mha_block_cached__dense_activation_squared_relu__decode'

def setup_inputs():

    _w = (lambda a: (lambda t: t.to(torch.bfloat16) if t.is_floating_point() else t)(torch.as_tensor(a)))
    def _A_setup():
        B, Sq, D = 1, 1, 448
        H, Sk, Dh = 16, 32768, 256
        return {
            "x": _w((lambda *s: torch.randn(*s, dtype=torch.bfloat16) * 0.05)(B, Sq, D)),
            "k_cache": _w((lambda *s: torch.randn(*s, dtype=torch.bfloat16) * 3.2)(B, H, Sk, Dh)),
            "v_cache": _w((lambda *s: torch.randn(*s, dtype=torch.bfloat16) * 0.4)(B, H, Sk, Dh)),
            "wq": _w((lambda *s: torch.randn(*s, dtype=torch.bfloat16) * 3.2)(D, H * Dh) * (D ** -0.5)),
            "wo": _w((lambda *s: torch.randn(*s, dtype=torch.bfloat16) * 0.4)(H * Dh, D) * ((H * Dh) ** -0.5)),
        }
    _A_in = _A_setup()

    def _B_setup():
        B, S, D, F = 1, 1, 448, 1792
        return {
            "x": _w((lambda *s: torch.randn(*s, dtype=torch.bfloat16) * 0.05)(B, S, D)),
            "w1": _w((lambda *s: torch.randn(*s, dtype=torch.bfloat16) * 0.05)(D, F)),
            "b1": _w((lambda *s: torch.randn(*s, dtype=torch.bfloat16) * 0.8)(F)),
            "w2": _w((lambda *s: torch.randn(*s, dtype=torch.bfloat16) * 0.05)(F, D)),
            "b2": _w((lambda *s: torch.randn(*s, dtype=torch.bfloat16) * 3.2)(D)),
        }
    _B_in = _B_setup()

    return {
        "A_x": _A_in["x"],
        "A_k_cache": _A_in["k_cache"],
        "A_v_cache": _A_in["v_cache"],
        "A_wq": _A_in["wq"],
        "A_wo": _A_in["wo"],
        "B_x": _B_in["x"],
        "B_w1": _B_in["w1"],
        "B_b1": _B_in["b1"],
        "B_w2": _B_in["w2"],
        "B_b2": _B_in["b2"],
    }

def reference(A_x, A_k_cache, A_v_cache, A_wq, A_wo, B_x, B_w1, B_b1, B_w2, B_b2):
    def _A_ref(x, k_cache, v_cache, wq, wo):
        B, Sq, D = x.shape
        H, Dh = 16, 256
        q = (lambda x, *d: x.permute(*d))((x @ wq).reshape(B, Sq, H, Dh), 0, 2, 1, 3)
        scores = torch.einsum("bhqd,bhkd->bhqk", q, k_cache) * (Dh ** -0.5)
        p = _softmax(scores, axis=-1)
        o = torch.einsum("bhqk,bhkd->bhqd", p, v_cache)
        return (lambda x, *d: x.permute(*d))(o, 0, 2, 1, 3).reshape(B, Sq, H * Dh) @ wo

    def _B_ref(x, w1, b1, w2, b2):
        h = torch.einsum("bsd,df->bsf", x, w1) + b1
        zero = torch.zeros_like(h)
        r = torch.where(h > zero, h, zero)
        h = r * r
        out = torch.einsum("bsf,fd->bsd", h, w2) + b2
        return out

    x = A_x
    h = x + _A_ref(_layernorm(x, axis=-1), A_k_cache, A_v_cache, A_wq, A_wo)
    h2 = h + _B_ref(_layernorm(h, axis=-1), B_w1, B_b1, B_w2, B_b2)
    return h2
```

```asm
; @launch grid=(256,1,1) block=(512,1,1) lds=155648
.amdgcn_target "amdgcn-amd-amdhsa--gfx950"
.text
.globl sequential_preLN__mha_block_cached__dense_activation_squared_relu__decode_kernel
.p2align 8
.type sequential_preLN__mha_block_cached__dense_activation_squared_relu__decode_kernel,@function
sequential_preLN__mha_block_cached__dense_activation_squared_relu__decode_kernel:
    s_cmp_ge_u32 s2, 256
    s_cbranch_scc1 L_exit
    s_load_dwordx16 s[64:79], s[0:1], 0
    s_load_dwordx8 s[80:87], s[0:1], 64
    s_load_dwordx2 s[88:89], s[0:1], 96
    v_and_b32 v1, 63, v0
    s_cmp_ge_u32 s2, 16
    s_cbranch_scc1 L_nocpf
    v_cmp_lt_u32 vcc, 447, v0
    s_cbranch_vccz L_nocpf
    s_getpc_b64 s[96:97]
L_pc:
    v_lshlrev_b32 v3, 7, v1
    s_mov_b32 s98, L_exit-L_pc
    v_cmp_gt_u32 vcc, s98, v3
    s_and_b64 exec, exec, vcc
    s_cbranch_execz L_cpfend
    global_load_dword v252, v3, s[96:97]
    v_add_u32 v3, 0x2000, v3
    v_cmp_gt_u32 vcc, s98, v3
    s_and_b64 exec, exec, vcc
    s_cbranch_execz L_cpfend
    global_load_dword v253, v3, s[96:97]
    v_add_u32 v3, 0x2000, v3
    v_cmp_gt_u32 vcc, s98, v3
    s_and_b64 exec, exec, vcc
    s_cbranch_execz L_cpfend
    global_load_dword v254, v3, s[96:97]
    v_add_u32 v3, 0x2000, v3
L_cpfend:
    s_mov_b64 exec, -1
L_nocpf:
    v_lshrrev_b32 v3, 6, v0
    v_lshrrev_b32 v7, 3, v1
    v_readfirstlane_b32 s24, v3
    v_lshlrev_b32 v7, 9, v7
    v_and_b32 v2, 7, v1
    v_lshlrev_b32 v2, 4, v2
    v_add_u32 v2, v2, v7
    s_lshr_b32 s25, s2, 4
    s_and_b32 s26, s2, 15
    s_lshl_b32 s29, s25, 24
    s_mov_b32 s59, s29
    s_mul_i32 s56, s25, 72
    s_mov_b32 s55, s24
    s_mov_b32 s32, 0
    s_mov_b32 s33, 0x3db8aa3b
    s_mov_b32 s30, 0x40000
    s_waitcnt lgkmcnt(0)
    s_mov_b32 s4, s66
    s_mov_b32 s5, s67
    s_mov_b32 s6, 0x10000000
    s_mov_b32 s7, 0x20000
    s_mov_b32 s8, s68
    s_mov_b32 s9, s69
    s_mov_b32 s10, 0x10000000
    s_mov_b32 s11, 0x20000
    s_mov_b32 s12, s88
    s_mov_b32 s13, s89
    s_mov_b32 s14, 0x40000000
    s_mov_b32 s15, 0x20000
    s_cmp_lg_u32 s24, 0
    s_cbranch_scc1 L_others
    s_setprio 3
    s_mov_b32 s16, s64
    s_mov_b32 s17, s65
    s_mov_b32 s18, 0x380
    s_mov_b32 s19, 0x20000
    s_mov_b32 s20, s70
    s_mov_b32 s21, s71
    s_mov_b32 s22, 0x380000
    s_mov_b32 s23, 0x20000
    v_mov_b32 v8, 0
    v_lshlrev_b32 v9, 1, v1
    buffer_load_ushort v88, v9, s[16:19], 0 offen offset:0 nt
    buffer_load_ushort v89, v9, s[16:19], 0 offen offset:128 nt
    buffer_load_ushort v90, v9, s[16:19], 0 offen offset:256 nt
    buffer_load_ushort v91, v9, s[16:19], 0 offen offset:384 nt
    buffer_load_ushort v92, v9, s[16:19], 0 offen offset:512 nt
    buffer_load_ushort v93, v9, s[16:19], 0 offen offset:640 nt
    buffer_load_ushort v94, v9, s[16:19], 0 offen offset:768 nt
    buffer_load_dword v95, v8, s[12:15], 0 offen sc1
    s_mul_i32 s44, s25, 4352
    s_add_u32 s44, s44, 0x1e8000
    s_cmp_lg_u32 s26, 0
    s_cbranch_scc1 L_nozero
    s_mov_b64 exec, 1
    buffer_store_dword v8, v8, s[12:15], s44 offen sc1
    s_mov_b64 exec, -1
L_nozero:
    s_and_b32 s43, s2, 3
    s_lshr_b32 s44, s2, 2
    s_lshl_b32 s44, s44, 7
    s_mul_i32 s45, s43, 917504
    s_add_u32 s44, s44, s45
    v_lshrrev_b32 v10, 3, v1
    v_lshlrev_b32 v10, 13, v10
    v_and_b32 v11, 7, v1
    v_lshlrev_b32 v11, 4, v11
    v_add3_u32 v10, v10, v11, s44
    s_mov_b32 s45, 0
    buffer_load_dwordx4 v[32:35], v10, s[20:23], s45 offen nt
    s_mov_b32 s45, 65536
    buffer_load_dwordx4 v[36:39], v10, s[20:23], s45 offen nt
    s_mov_b32 s45, 131072
    buffer_load_dwordx4 v[40:43], v10, s[20:23], s45 offen nt
    s_mov_b32 s45, 196608
    buffer_load_dwordx4 v[44:47], v10, s[20:23], s45 offen nt
    s_mov_b32 s45, 262144
    buffer_load_dwordx4 v[48:51], v10, s[20:23], s45 offen nt
    s_mov_b32 s45, 327680
    buffer_load_dwordx4 v[52:55], v10, s[20:23], s45 offen nt
    s_mov_b32 s45, 393216
    buffer_load_dwordx4 v[56:59], v10, s[20:23], s45 offen nt
    s_mov_b32 s45, 458752
    buffer_load_dwordx4 v[60:63], v10, s[20:23], s45 offen nt
    s_mov_b32 s45, 524288
    buffer_load_dwordx4 v[64:67], v10, s[20:23], s45 offen nt
    s_mov_b32 s45, 589824
    buffer_load_dwordx4 v[68:71], v10, s[20:23], s45 offen nt
    s_mov_b32 s45, 655360
    buffer_load_dwordx4 v[72:75], v10, s[20:23], s45 offen nt
    s_mov_b32 s45, 720896
    buffer_load_dwordx4 v[76:79], v10, s[20:23], s45 offen nt
    s_mov_b32 s45, 786432
    buffer_load_dwordx4 v[80:83], v10, s[20:23], s45 offen nt
    s_mov_b32 s45, 851968
    buffer_load_dwordx4 v[84:87], v10, s[20:23], s45 offen nt
    s_barrier
    s_waitcnt vmcnt(15)
    v_lshlrev_b32 v88, 16, v88
    v_lshlrev_b32 v89, 16, v89
    v_lshlrev_b32 v90, 16, v90
    v_lshlrev_b32 v91, 16, v91
    v_lshlrev_b32 v92, 16, v92
    v_lshlrev_b32 v93, 16, v93
    v_lshlrev_b32 v94, 16, v94
    v_readfirstlane_b32 s37, v88
    v_mov_b32 v225, 0
    v_mov_b32 v226, 0
    v_subrev_f32 v227, s37, v88
    v_add_f32 v225, v225, v227
    v_fmac_f32 v226, v227, v227
    v_subrev_f32 v227, s37, v89
    v_add_f32 v225, v225, v227
    v_fmac_f32 v226, v227, v227
    v_subrev_f32 v227, s37, v90
    v_add_f32 v225, v225, v227
    v_fmac_f32 v226, v227, v227
    v_subrev_f32 v227, s37, v91
    v_add_f32 v225, v225, v227
    v_fmac_f32 v226, v227, v227
    v_subrev_f32 v227, s37, v92
    v_add_f32 v225, v225, v227
    v_fmac_f32 v226, v227, v227
    v_subrev_f32 v227, s37, v93
    v_add_f32 v225, v225, v227
    v_fmac_f32 v226, v227, v227
    v_subrev_f32 v227, s37, v94
    v_add_f32 v225, v225, v227
    v_fmac_f32 v226, v227, v227
    s_nop 1
    v_add_f32_dpp v225, v225, v225 row_ror:8 row_mask:0xf bank_mask:0xf
    v_add_f32_dpp v226, v226, v226 row_ror:8 row_mask:0xf bank_mask:0xf
    s_nop 0
    v_add_f32_dpp v225, v225, v225 row_ror:4 row_mask:0xf bank_mask:0xf
    v_add_f32_dpp v226, v226, v226 row_ror:4 row_mask:0xf bank_mask:0xf
    s_nop 0
    v_add_f32_dpp v225, v225, v225 row_ror:2 row_mask:0xf bank_mask:0xf
    v_add_f32_dpp v226, v226, v226 row_ror:2 row_mask:0xf bank_mask:0xf
    s_nop 0
    v_add_f32_dpp v225, v225, v225 row_ror:1 row_mask:0xf bank_mask:0xf
    v_add_f32_dpp v226, v226, v226 row_ror:1 row_mask:0xf bank_mask:0xf
    s_nop 0
    v_add_f32_dpp v225, v225, v225 row_bcast:15 row_mask:0xa bank_mask:0xf
    v_add_f32_dpp v226, v226, v226 row_bcast:15 row_mask:0xa bank_mask:0xf
    s_nop 0
    v_add_f32_dpp v225, v225, v225 row_bcast:31 row_mask:0xc bank_mask:0xf
    v_add_f32_dpp v226, v226, v226 row_bcast:31 row_mask:0xc bank_mask:0xf
    s_nop 0
    v_readlane_b32 s38, v225, 63
    v_readlane_b32 s39, v226, 63
    s_nop 1
    s_mov_b32 s40, 0x3b124925
    v_mov_b32 v227, s38
    v_mov_b32 v226, s39
    v_mul_f32 v227, s40, v227
    v_mul_f32 v226, s40, v226
    v_add_f32 v228, s37, v227
    v_fma_f32 v226, -v227, v227, v226
    v_max_f32 v226, 0, v226
    v_cvt_pk_bf16_f32 v228, v228, v228
    v_and_b32 v228, 0xffff0000, v228
    v_cvt_pk_bf16_f32 v226, v226, v226
    v_and_b32 v226, 0xffff0000, v226
    v_add_f32 v226, 0x3727c5ac, v226
    v_cvt_pk_bf16_f32 v226, v226, v226
    v_and_b32 v226, 0xffff0000, v226
    v_sqrt_f32 v226, v226
    v_sub_f32 v88, v88, v228
    v_sub_f32 v89, v89, v228
    v_sub_f32 v90, v90, v228
    v_sub_f32 v91, v91, v228
    v_sub_f32 v92, v92, v228
    v_sub_f32 v93, v93, v228
    v_sub_f32 v94, v94, v228
    v_cvt_pk_bf16_f32 v226, v226, v226
    v_and_b32 v226, 0xffff0000, v226
    v_rcp_f32 v229, v226
    v_cvt_pk_bf16_f32 v88, v88, v88
    v_and_b32 v88, 0xffff0000, v88
    v_cvt_pk_bf16_f32 v89, v89, v89
    v_and_b32 v89, 0xffff0000, v89
    v_cvt_pk_bf16_f32 v90, v90, v90
    v_and_b32 v90, 0xffff0000, v90
    v_cvt_pk_bf16_f32 v91, v91, v91
    v_and_b32 v91, 0xffff0000, v91
    v_cvt_pk_bf16_f32 v92, v92, v92
    v_and_b32 v92, 0xffff0000, v92
    v_cvt_pk_bf16_f32 v93, v93, v93
    v_and_b32 v93, 0xffff0000, v93
    v_cvt_pk_bf16_f32 v94, v94, v94
    v_and_b32 v94, 0xffff0000, v94
    v_mul_f32 v227, v88, v229
    v_fma_f32 v88, -v227, v226, v88
    v_fma_f32 v88, v88, v229, v227
    v_mul_f32 v227, v89, v229
    v_fma_f32 v89, -v227, v226, v89
    v_fma_f32 v89, v89, v229, v227
    v_mul_f32 v227, v90, v229
    v_fma_f32 v90, -v227, v226, v90
    v_fma_f32 v90, v90, v229, v227
    v_mul_f32 v227, v91, v229
    v_fma_f32 v91, -v227, v226, v91
    v_fma_f32 v91, v91, v229, v227
    v_mul_f32 v227, v92, v229
    v_fma_f32 v92, -v227, v226, v92
    v_fma_f32 v92, v92, v229, v227
    v_mul_f32 v227, v93, v229
    v_fma_f32 v93, -v227, v226, v93
    v_fma_f32 v93, v93, v229, v227
    v_mul_f32 v227, v94, v229
    v_fma_f32 v94, -v227, v226, v94
    v_fma_f32 v94, v94, v229, v227
    v_cvt_pk_bf16_f32 v88, v88, v88
    v_and_b32 v88, 0xffff0000, v88
    v_cvt_pk_bf16_f32 v89, v89, v89
    v_and_b32 v89, 0xffff0000, v89
    v_cvt_pk_bf16_f32 v90, v90, v90
    v_and_b32 v90, 0xffff0000, v90
    v_cvt_pk_bf16_f32 v91, v91, v91
    v_and_b32 v91, 0xffff0000, v91
    v_cvt_pk_bf16_f32 v92, v92, v92
    v_and_b32 v92, 0xffff0000, v92
    v_cvt_pk_bf16_f32 v93, v93, v93
    v_and_b32 v93, 0xffff0000, v93
    v_cvt_pk_bf16_f32 v94, v94, v94
    v_and_b32 v94, 0xffff0000, v94
    v_lshlrev_b32 v9, 2, v1
    ds_write_b32 v9, v88 offset:12288
    ds_write_b32 v9, v89 offset:12544
    ds_write_b32 v9, v90 offset:12800
    ds_write_b32 v9, v91 offset:13056
    ds_write_b32 v9, v92 offset:13312
    ds_write_b32 v9, v93 offset:13568
    ds_write_b32 v9, v94 offset:13824
    s_mul_i32 s45, s43, 448
    v_lshrrev_b32 v9, 3, v1
    v_lshlrev_b32 v9, 2, v9
    v_add_u32 v9, s45, v9
    s_waitcnt lgkmcnt(0)
    ds_read_b32 v224, v9 offset:12288
    ds_read_b32 v225, v9 offset:12320
    ds_read_b32 v226, v9 offset:12352
    ds_read_b32 v227, v9 offset:12384
    ds_read_b32 v228, v9 offset:12416
    ds_read_b32 v229, v9 offset:12448
    ds_read_b32 v230, v9 offset:12480
    ds_read_b32 v231, v9 offset:12512
    ds_read_b32 v232, v9 offset:12544
    ds_read_b32 v233, v9 offset:12576
    ds_read_b32 v234, v9 offset:12608
    ds_read_b32 v235, v9 offset:12640
    ds_read_b32 v236, v9 offset:12672
    ds_read_b32 v237, v9 offset:12704
    s_waitcnt vmcnt(14)
    v_readfirstlane_b32 s28, v95
    v_mov_b32 v16, 0
    v_mov_b32 v17, 0
    v_mov_b32 v18, 0
    v_mov_b32 v19, 0
    v_mov_b32 v20, 0
    v_mov_b32 v21, 0
    v_mov_b32 v22, 0
    v_mov_b32 v23, 0
    s_mul_i32 s27, s28, 0x9E3779B1
    s_add_u32 s27, s27, 0x85EBCA6B
    s_waitcnt vmcnt(0) lgkmcnt(0)
    v_lshrrev_b32 v238, 16, v224
    v_dot2c_f32_bf16 v16, v32, v238
    v_dot2c_f32_bf16 v17, v32, v224
    v_dot2c_f32_bf16 v18, v33, v238
    v_dot2c_f32_bf16 v19, v33, v224
    v_dot2c_f32_bf16 v20, v34, v238
    v_dot2c_f32_bf16 v21, v34, v224
    v_dot2c_f32_bf16 v22, v35, v238
    v_dot2c_f32_bf16 v23, v35, v224
    v_lshrrev_b32 v239, 16, v225
    v_dot2c_f32_bf16 v16, v36, v239
    v_dot2c_f32_bf16 v17, v36, v225
    v_dot2c_f32_bf16 v18, v37, v239
    v_dot2c_f32_bf16 v19, v37, v225
    v_dot2c_f32_bf16 v20, v38, v239
    v_dot2c_f32_bf16 v21, v38, v225
    v_dot2c_f32_bf16 v22, v39, v239
    v_dot2c_f32_bf16 v23, v39, v225
    v_lshrrev_b32 v238, 16, v226
    v_dot2c_f32_bf16 v16, v40, v238
    v_dot2c_f32_bf16 v17, v40, v226
    v_dot2c_f32_bf16 v18, v41, v238
    v_dot2c_f32_bf16 v19, v41, v226
    v_dot2c_f32_bf16 v20, v42, v238
    v_dot2c_f32_bf16 v21, v42, v226
    v_dot2c_f32_bf16 v22, v43, v238
    v_dot2c_f32_bf16 v23, v43, v226
    v_lshrrev_b32 v239, 16, v227
    v_dot2c_f32_bf16 v16, v44, v239
    v_dot2c_f32_bf16 v17, v44, v227
    v_dot2c_f32_bf16 v18, v45, v239
    v_dot2c_f32_bf16 v19, v45, v227
    v_dot2c_f32_bf16 v20, v46, v239
    v_dot2c_f32_bf16 v21, v46, v227
    v_dot2c_f32_bf16 v22, v47, v239
    v_dot2c_f32_bf16 v23, v47, v227
    v_lshrrev_b32 v238, 16, v228
    v_dot2c_f32_bf16 v16, v48, v238
    v_dot2c_f32_bf16 v17, v48, v228
    v_dot2c_f32_bf16 v18, v49, v238
    v_dot2c_f32_bf16 v19, v49, v228
    v_dot2c_f32_bf16 v20, v50, v238
    v_dot2c_f32_bf16 v21, v50, v228
    v_dot2c_f32_bf16 v22, v51, v238
    v_dot2c_f32_bf16 v23, v51, v228
    v_lshrrev_b32 v239, 16, v229
    v_dot2c_f32_bf16 v16, v52, v239
    v_dot2c_f32_bf16 v17, v52, v229
    v_dot2c_f32_bf16 v18, v53, v239
    v_dot2c_f32_bf16 v19, v53, v229
    v_dot2c_f32_bf16 v20, v54, v239
    v_dot2c_f32_bf16 v21, v54, v229
    v_dot2c_f32_bf16 v22, v55, v239
    v_dot2c_f32_bf16 v23, v55, v229
    v_lshrrev_b32 v238, 16, v230
    v_dot2c_f32_bf16 v16, v56, v238
    v_dot2c_f32_bf16 v17, v56, v230
    v_dot2c_f32_bf16 v18, v57, v238
    v_dot2c_f32_bf16 v19, v57, v230
    v_dot2c_f32_bf16 v20, v58, v238
    v_dot2c_f32_bf16 v21, v58, v230
    v_dot2c_f32_bf16 v22, v59, v238
    v_dot2c_f32_bf16 v23, v59, v230
    v_lshrrev_b32 v239, 16, v231
    v_dot2c_f32_bf16 v16, v60, v239
    v_dot2c_f32_bf16 v17, v60, v231
    v_dot2c_f32_bf16 v18, v61, v239
    v_dot2c_f32_bf16 v19, v61, v231
    v_dot2c_f32_bf16 v20, v62, v239
    v_dot2c_f32_bf16 v21, v62, v231
    v_dot2c_f32_bf16 v22, v63, v239
    v_dot2c_f32_bf16 v23, v63, v231
    v_lshrrev_b32 v238, 16, v232
    v_dot2c_f32_bf16 v16, v64, v238
    v_dot2c_f32_bf16 v17, v64, v232
    v_dot2c_f32_bf16 v18, v65, v238
    v_dot2c_f32_bf16 v19, v65, v232
    v_dot2c_f32_bf16 v20, v66, v238
    v_dot2c_f32_bf16 v21, v66, v232
    v_dot2c_f32_bf16 v22, v67, v238
    v_dot2c_f32_bf16 v23, v67, v232
    v_lshrrev_b32 v239, 16, v233
    v_dot2c_f32_bf16 v16, v68, v239
    v_dot2c_f32_bf16 v17, v68, v233
    v_dot2c_f32_bf16 v18, v69, v239
    v_dot2c_f32_bf16 v19, v69, v233
    v_dot2c_f32_bf16 v20, v70, v239
    v_dot2c_f32_bf16 v21, v70, v233
    v_dot2c_f32_bf16 v22, v71, v239
    v_dot2c_f32_bf16 v23, v71, v233
    v_lshrrev_b32 v238, 16, v234
    v_dot2c_f32_bf16 v16, v72, v238
    v_dot2c_f32_bf16 v17, v72, v234
    v_dot2c_f32_bf16 v18, v73, v238
    v_dot2c_f32_bf16 v19, v73, v234
    v_dot2c_f32_bf16 v20, v74, v238
    v_dot2c_f32_bf16 v21, v74, v234
    v_dot2c_f32_bf16 v22, v75, v238
    v_dot2c_f32_bf16 v23, v75, v234
    v_lshrrev_b32 v239, 16, v235
    v_dot2c_f32_bf16 v16, v76, v239
    v_dot2c_f32_bf16 v17, v76, v235
    v_dot2c_f32_bf16 v18, v77, v239
    v_dot2c_f32_bf16 v19, v77, v235
    v_dot2c_f32_bf16 v20, v78, v239
    v_dot2c_f32_bf16 v21, v78, v235
    v_dot2c_f32_bf16 v22, v79, v239
    v_dot2c_f32_bf16 v23, v79, v235
    v_lshrrev_b32 v238, 16, v236
    v_dot2c_f32_bf16 v16, v80, v238
    v_dot2c_f32_bf16 v17, v80, v236
    v_dot2c_f32_bf16 v18, v81, v238
    v_dot2c_f32_bf16 v19, v81, v236
    v_dot2c_f32_bf16 v20, v82, v238
    v_dot2c_f32_bf16 v21, v82, v236
    v_dot2c_f32_bf16 v22, v83, v238
    v_dot2c_f32_bf16 v23, v83, v236
    v_lshrrev_b32 v239, 16, v237
    v_dot2c_f32_bf16 v16, v84, v239
    v_dot2c_f32_bf16 v17, v84, v237
    v_dot2c_f32_bf16 v18, v85, v239
    v_dot2c_f32_bf16 v19, v85, v237
    v_dot2c_f32_bf16 v20, v86, v239
    v_dot2c_f32_bf16 v21, v86, v237
    v_dot2c_f32_bf16 v22, v87, v239
    v_dot2c_f32_bf16 v23, v87, v237
    s_nop 2
    v_permlane32_swap_b32 v16, v20
    v_permlane32_swap_b32 v17, v21
    v_permlane32_swap_b32 v18, v22
    v_permlane32_swap_b32 v19, v23
    s_nop 0
    v_pk_add_f32 v[16:17], v[16:17], v[20:21]
    v_pk_add_f32 v[18:19], v[18:19], v[22:23]
    s_nop 1
    v_permlane16_swap_b32 v16, v18
    v_permlane16_swap_b32 v17, v19
    s_nop 0
    v_pk_add_f32 v[16:17], v[16:17], v[18:19]
    s_nop 1
    v_add_f32_dpp v16, v16, v16 row_ror:8 row_mask:0xf bank_mask:0x3
    v_add_f32_dpp v16, v17, v17 row_ror:8 row_mask:0xf bank_mask:0xc
    s_nop 1
    v_mov_b32_dpp v18, v16 row_ror:8 row_mask:0xf bank_mask:0xf
    v_mov_b32 v17, s27
    v_mov_b32 v19, s27
    v_and_b32 v9, 7, v1
    v_lshlrev_b32 v9, 6, v9
    v_lshrrev_b32 v11, 3, v1
    v_lshlrev_b32 v11, 3, v11
    v_add_u32 v9, v9, v11
    s_lshl_b32 s44, s25, 13
    s_lshl_b32 s45, s43, 11
    s_add_u32 s44, s44, s45
    s_lshr_b32 s45, s26, 2
    s_lshl_b32 s45, s45, 9
    s_add_u32 s44, s44, s45
    s_add_u32 s44, s44, 0xd0000
    s_mov_b32 exec_lo, 0x00ff00ff
    s_mov_b32 exec_hi, 0x00ff00ff
    buffer_store_dwordx4 v[16:19], v9, s[12:15], s44 offen sc1
    s_mov_b64 exec, -1
    v_lshlrev_b32 v9, 4, v1
    s_lshl_b32 s44, s25, 13
    s_add_u32 s44, s44, 0xd0000
    v_add_u32 v9, s44, v9
    v_lshlrev_b32 v11, 4, v1
    v_mov_b32 v240, 0
    v_mov_b32 v241, 0
    v_mov_b32 v242, 0
    v_mov_b32 v243, 0
    ds_write_b128 v11, v[240:243] offset:10752
    s_mul_i32 s49, s32, 0
    s_add_u32 s49, s49, s26
    s_and_b32 s49, s49, 15
    s_lshl_b32 s47, s32, 4
    s_add_u32 s49, s49, s47
    s_and_b32 s46, s49, 7
    s_lshl_b32 s46, s46, 6
    s_lshr_b32 s47, s49, 3
    s_add_u32 s46, s46, s47
    s_add_u32 s46, s46, s56
    s_and_b32 s46, s46, 511
    s_lshl_b32 s46, s46, 3
    s_add_u32 s46, s46, s55
    s_lshl_b32 s46, s46, 12
    s_add_u32 s46, s46, s29
    v_add_u32 v12, s46, v2
    s_add_u32 s32, s32, 1
    buffer_load_dwordx4 v[96:99], v12, s[4:7], 0 offen nt
    buffer_load_dwordx4 v[100:103], v12, s[4:7], 0 offen offset:128 nt
    buffer_load_dwordx4 v[104:107], v12, s[4:7], 0 offen offset:256 nt
    buffer_load_dwordx4 v[108:111], v12, s[4:7], 0 offen offset:384 nt
    buffer_load_dwordx4 v[112:115], v12, s[8:11], 0 offen nt
    buffer_load_dwordx4 v[116:119], v12, s[8:11], 0 offen offset:128 nt
    buffer_load_dwordx4 v[120:123], v12, s[8:11], 0 offen offset:256 nt
    buffer_load_dwordx4 v[124:127], v12, s[8:11], 0 offen offset:384 nt
    s_mul_i32 s49, s32, 0
    s_add_u32 s49, s49, s26
    s_and_b32 s49, s49, 15
    s_lshl_b32 s47, s32, 4
    s_add_u32 s49, s49, s47
    s_and_b32 s46, s49, 7
    s_lshl_b32 s46, s46, 6
    s_lshr_b32 s47, s49, 3
    s_add_u32 s46, s46, s47
    s_add_u32 s46, s46, s56
    s_and_b32 s46, s46, 511
    s_lshl_b32 s46, s46, 3
    s_add_u32 s46, s46, s55
    s_lshl_b32 s46, s46, 12
    s_add_u32 s46, s46, s29
    v_add_u32 v13, s46, v2
    s_add_u32 s32, s32, 1
    buffer_load_dwordx4 v[128:131], v13, s[4:7], 0 offen nt
    buffer_load_dwordx4 v[132:135], v13, s[4:7], 0 offen offset:128 nt
    buffer_load_dwordx4 v[136:139], v13, s[4:7], 0 offen offset:256 nt
    buffer_load_dwordx4 v[140:143], v13, s[4:7], 0 offen offset:384 nt
    buffer_load_dwordx4 v[144:147], v13, s[8:11], 0 offen nt
    buffer_load_dwordx4 v[148:151], v13, s[8:11], 0 offen offset:128 nt
    buffer_load_dwordx4 v[152:155], v13, s[8:11], 0 offen offset:256 nt
    buffer_load_dwordx4 v[156:159], v13, s[8:11], 0 offen offset:384 nt
    s_mul_i32 s49, s32, 0
    s_add_u32 s49, s49, s26
    s_and_b32 s49, s49, 15
    s_lshl_b32 s47, s32, 4
    s_add_u32 s49, s49, s47
    s_and_b32 s46, s49, 7
    s_lshl_b32 s46, s46, 6
    s_lshr_b32 s47, s49, 3
    s_add_u32 s46, s46, s47
    s_add_u32 s46, s46, s56
    s_and_b32 s46, s46, 511
    s_lshl_b32 s46, s46, 3
    s_add_u32 s46, s46, s55
    s_lshl_b32 s46, s46, 12
    s_add_u32 s46, s46, s29
    v_add_u32 v14, s46, v2
    s_add_u32 s32, s32, 1
    buffer_load_dwordx4 v[160:163], v14, s[4:7], 0 offen nt
    buffer_load_dwordx4 v[164:167], v14, s[4:7], 0 offen offset:128 nt
    buffer_load_dwordx4 v[168:171], v14, s[4:7], 0 offen offset:256 nt
    buffer_load_dwordx4 v[172:175], v14, s[4:7], 0 offen offset:384 nt
    buffer_load_dwordx4 v[176:179], v14, s[8:11], 0 offen nt
    buffer_load_dwordx4 v[180:183], v14, s[8:11], 0 offen offset:128 nt
    buffer_load_dwordx4 v[184:187], v14, s[8:11], 0 offen offset:256 nt
    buffer_load_dwordx4 v[188:191], v14, s[8:11], 0 offen offset:384 nt
    s_movk_i32 s45, 0
    buffer_load_dwordx4 v[32:35], v9, s[12:15], s45 offen sc1
    buffer_load_dwordx4 v[36:39], v9, s[12:15], s45 offen offset:1024 sc1
    s_movk_i32 s45, 2048
    buffer_load_dwordx4 v[40:43], v9, s[12:15], s45 offen sc1
    buffer_load_dwordx4 v[44:47], v9, s[12:15], s45 offen offset:1024 sc1
    s_movk_i32 s45, 4096
    buffer_load_dwordx4 v[48:51], v9, s[12:15], s45 offen sc1
    buffer_load_dwordx4 v[52:55], v9, s[12:15], s45 offen offset:1024 sc1
    s_movk_i32 s45, 6144
    buffer_load_dwordx4 v[56:59], v9, s[12:15], s45 offen sc1
    buffer_load_dwordx4 v[60:63], v9, s[12:15], s45 offen offset:1024 sc1
    s_barrier
    s_waitcnt vmcnt(0)
    v_xor_b32 v229, s27, v33
    v_xor_b32 v230, s27, v37
    v_or_b32 v229, v229, v230
    v_xor_b32 v230, s27, v41
    v_or_b32 v229, v229, v230
    v_xor_b32 v230, s27, v45
    v_or_b32 v229, v229, v230
    v_xor_b32 v230, s27, v49
    v_or_b32 v229, v229, v230
    v_xor_b32 v230, s27, v53
    v_or_b32 v229, v229, v230
    v_xor_b32 v230, s27, v57
    v_or_b32 v229, v229, v230
    v_xor_b32 v230, s27, v61
    v_or_b32 v229, v229, v230
    v_xor_b32 v230, s27, v35
    v_or_b32 v229, v229, v230
    v_xor_b32 v230, s27, v39
    v_or_b32 v229, v229, v230
    v_xor_b32 v230, s27, v43
    v_or_b32 v229, v229, v230
    v_xor_b32 v230, s27, v47
    v_or_b32 v229, v229, v230
    v_xor_b32 v230, s27, v51
    v_or_b32 v229, v229, v230
    v_xor_b32 v230, s27, v55
    v_or_b32 v229, v229, v230
    v_xor_b32 v230, s27, v59
    v_or_b32 v229, v229, v230
    v_xor_b32 v230, s27, v63
    v_or_b32 v229, v229, v230
    v_cmp_ne_u32 vcc, 0, v229
    s_cbranch_vccz L_qok
    s_sub_u32 s30, s30, 1
L_poll_1:
    s_movk_i32 s45, 0
    buffer_load_dwordx4 v[32:35], v9, s[12:15], s45 offen sc1
    buffer_load_dwordx4 v[36:39], v9, s[12:15], s45 offen offset:1024 sc1
    s_movk_i32 s45, 2048
    buffer_load_dwordx4 v[40:43], v9, s[12:15], s45 offen sc1
    buffer_load_dwordx4 v[44:47], v9, s[12:15], s45 offen offset:1024 sc1
    s_movk_i32 s45, 4096
    buffer_load_dwordx4 v[48:51], v9, s[12:15], s45 offen sc1
    buffer_load_dwordx4 v[52:55], v9, s[12:15], s45 offen offset:1024 sc1
    s_movk_i32 s45, 6144
    buffer_load_dwordx4 v[56:59], v9, s[12:15], s45 offen sc1
    buffer_load_dwordx4 v[60:63], v9, s[12:15], s45 offen offset:1024 sc1
    s_waitcnt vmcnt(0)
    v_xor_b32 v229, s27, v33
    v_xor_b32 v230, s27, v37
    v_or_b32 v229, v229, v230
    v_xor_b32 v230, s27, v41
    v_or_b32 v229, v229, v230
    v_xor_b32 v230, s27, v45
    v_or_b32 v229, v229, v230
    v_xor_b32 v230, s27, v49
    v_or_b32 v229, v229, v230
    v_xor_b32 v230, s27, v53
    v_or_b32 v229, v229, v230
    v_xor_b32 v230, s27, v57
    v_or_b32 v229, v229, v230
    v_xor_b32 v230, s27, v61
    v_or_b32 v229, v229, v230
    v_xor_b32 v230, s27, v35
    v_or_b32 v229, v229, v230
    v_xor_b32 v230, s27, v39
    v_or_b32 v229, v229, v230
    v_xor_b32 v230, s27, v43
    v_or_b32 v229, v229, v230
    v_xor_b32 v230, s27, v47
    v_or_b32 v229, v229, v230
    v_xor_b32 v230, s27, v51
    v_or_b32 v229, v229, v230
    v_xor_b32 v230, s27, v55
    v_or_b32 v229, v229, v230
    v_xor_b32 v230, s27, v59
    v_or_b32 v229, v229, v230
    v_xor_b32 v230, s27, v63
    v_or_b32 v229, v229, v230
    v_cmp_ne_u32 vcc, 0, v229
    s_cbranch_vccz L_ok_2
    s_sub_u32 s30, s30, 1
    s_cbranch_scc0 L_poll_1
    s_mov_b32 s30, 0
L_ok_2:
L_qok:
    v_add_f32 v32, v32, v40
    v_add_f32 v48, v48, v56
    v_add_f32 v32, v32, v48
    v_add_f32 v34, v34, v42
    v_add_f32 v50, v50, v58
    v_add_f32 v34, v34, v50
    v_cvt_pk_bf16_f32 v232, v32, v34
    v_add_f32 v36, v36, v44
    v_add_f32 v52, v52, v60
    v_add_f32 v36, v36, v52
    v_add_f32 v38, v38, v46
    v_add_f32 v54, v54, v62
    v_add_f32 v38, v38, v54
    v_cvt_pk_bf16_f32 v233, v36, v38
    v_lshlrev_b32 v9, 2, v1
    ds_write_b32 v9, v232 offset:0
    ds_write_b32 v9, v233 offset:256
    v_mov_b32 v236, s27
    v_mov_b32 v237, s28
    v_mov_b32 v231, 0
    ds_write_b64 v231, v[236:237] offset:512
    s_mul_i32 s49, s32, 0
    s_add_u32 s49, s49, s26
    s_and_b32 s49, s49, 15
    s_lshl_b32 s47, s32, 4
    s_add_u32 s49, s49, s47
    s_and_b32 s46, s49, 7
    s_lshl_b32 s46, s46, 6
    s_lshr_b32 s47, s49, 3
    s_add_u32 s46, s46, s47
    s_add_u32 s46, s46, s56
    s_and_b32 s46, s46, 511
    s_lshl_b32 s46, s46, 3
    s_add_u32 s46, s46, s55
    s_lshl_b32 s46, s46, 12
    s_add_u32 s46, s46, s29
    v_add_u32 v15, s46, v2
    s_add_u32 s32, s32, 1
    buffer_load_dwordx4 v[192:195], v15, s[4:7], 0 offen nt
    buffer_load_dwordx4 v[196:199], v15, s[4:7], 0 offen offset:128 nt
    buffer_load_dwordx4 v[200:203], v15, s[4:7], 0 offen offset:256 nt
    buffer_load_dwordx4 v[204:207], v15, s[4:7], 0 offen offset:384 nt
    buffer_load_dwordx4 v[208:211], v15, s[8:11], 0 offen nt
    buffer_load_dwordx4 v[212:215], v15, s[8:11], 0 offen offset:128 nt
    buffer_load_dwordx4 v[216:219], v15, s[8:11], 0 offen offset:256 nt
    buffer_load_dwordx4 v[220:223], v15, s[8:11], 0 offen offset:384 nt
    s_mul_i32 s49, s32, 0
    s_add_u32 s49, s49, s26
    s_and_b32 s49, s49, 15
    s_lshl_b32 s47, s32, 4
    s_add_u32 s49, s49, s47
    s_and_b32 s46, s49, 7
    s_lshl_b32 s46, s46, 6
    s_lshr_b32 s47, s49, 3
    s_add_u32 s46, s46, s47
    s_add_u32 s46, s46, s56
    s_and_b32 s46, s46, 511
    s_lshl_b32 s46, s46, 3
    s_add_u32 s46, s46, s55
    s_lshl_b32 s46, s46, 12
    s_add_u32 s46, s46, s29
    v_add_u32 v3, s46, v2
    s_add_u32 s32, s32, 1
    buffer_load_dwordx4 v[64:67], v3, s[4:7], 0 offen nt
    buffer_load_dwordx4 v[68:71], v3, s[4:7], 0 offen offset:128 nt
    buffer_load_dwordx4 v[72:75], v3, s[4:7], 0 offen offset:256 nt
    buffer_load_dwordx4 v[76:79], v3, s[4:7], 0 offen offset:384 nt
    buffer_load_dwordx4 v[80:83], v3, s[8:11], 0 offen nt
    buffer_load_dwordx4 v[84:87], v3, s[8:11], 0 offen offset:128 nt
    buffer_load_dwordx4 v[88:91], v3, s[8:11], 0 offen offset:256 nt
    buffer_load_dwordx4 v[92:95], v3, s[8:11], 0 offen offset:384 nt
    s_setprio 0
    s_waitcnt lgkmcnt(0)
    s_branch L_waitq
L_others:
    s_barrier
    s_mul_i32 s49, s32, 0
    s_add_u32 s49, s49, s26
    s_and_b32 s49, s49, 15
    s_lshl_b32 s47, s32, 4
    s_add_u32 s49, s49, s47
    s_and_b32 s46, s49, 7
    s_lshl_b32 s46, s46, 6
    s_lshr_b32 s47, s49, 3
    s_add_u32 s46, s46, s47
    s_add_u32 s46, s46, s56
    s_and_b32 s46, s46, 511
    s_lshl_b32 s46, s46, 3
    s_add_u32 s46, s46, s55
    s_lshl_b32 s46, s46, 12
    s_add_u32 s46, s46, s29
    v_add_u32 v12, s46, v2
    s_add_u32 s32, s32, 1
    buffer_load_dwordx4 v[96:99], v12, s[4:7], 0 offen nt
    buffer_load_dwordx4 v[100:103], v12, s[4:7], 0 offen offset:128 nt
    buffer_load_dwordx4 v[104:107], v12, s[4:7], 0 offen offset:256 nt
    buffer_load_dwordx4 v[108:111], v12, s[4:7], 0 offen offset:384 nt
    buffer_load_dwordx4 v[112:115], v12, s[8:11], 0 offen nt
    buffer_load_dwordx4 v[116:119], v12, s[8:11], 0 offen offset:128 nt
    buffer_load_dwordx4 v[120:123], v12, s[8:11], 0 offen offset:256 nt
    buffer_load_dwordx4 v[124:127], v12, s[8:11], 0 offen offset:384 nt
    s_mul_i32 s49, s32, 0
    s_add_u32 s49, s49, s26
    s_and_b32 s49, s49, 15
    s_lshl_b32 s47, s32, 4
    s_add_u32 s49, s49, s47
    s_and_b32 s46, s49, 7
    s_lshl_b32 s46, s46, 6
    s_lshr_b32 s47, s49, 3
    s_add_u32 s46, s46, s47
    s_add_u32 s46, s46, s56
    s_and_b32 s46, s46, 511
    s_lshl_b32 s46, s46, 3
    s_add_u32 s46, s46, s55
    s_lshl_b32 s46, s46, 12
    s_add_u32 s46, s46, s29
    v_add_u32 v13, s46, v2
    s_add_u32 s32, s32, 1
    buffer_load_dwordx4 v[128:131], v13, s[4:7], 0 offen nt
    buffer_load_dwordx4 v[132:135], v13, s[4:7], 0 offen offset:128 nt
    buffer_load_dwordx4 v[136:139], v13, s[4:7], 0 offen offset:256 nt
    buffer_load_dwordx4 v[140:143], v13, s[4:7], 0 offen offset:384 nt
    buffer_load_dwordx4 v[144:147], v13, s[8:11], 0 offen nt
    buffer_load_dwordx4 v[148:151], v13, s[8:11], 0 offen offset:128 nt
    buffer_load_dwordx4 v[152:155], v13, s[8:11], 0 offen offset:256 nt
    buffer_load_dwordx4 v[156:159], v13, s[8:11], 0 offen offset:384 nt
    s_barrier
    s_mul_i32 s49, s32, 0
    s_add_u32 s49, s49, s26
    s_and_b32 s49, s49, 15
    s_lshl_b32 s47, s32, 4
    s_add_u32 s49, s49, s47
    s_and_b32 s46, s49, 7
    s_lshl_b32 s46, s46, 6
    s_lshr_b32 s47, s49, 3
    s_add_u32 s46, s46, s47
    s_add_u32 s46, s46, s56
    s_and_b32 s46, s46, 511
    s_lshl_b32 s46, s46, 3
    s_add_u32 s46, s46, s55
    s_lshl_b32 s46, s46, 12
    s_add_u32 s46, s46, s29
    v_add_u32 v14, s46, v2
    s_add_u32 s32, s32, 1
    buffer_load_dwordx4 v[160:163], v14, s[4:7], 0 offen nt
    buffer_load_dwordx4 v[164:167], v14, s[4:7], 0 offen offset:128 nt
    buffer_load_dwordx4 v[168:171], v14, s[4:7], 0 offen offset:256 nt
    buffer_load_dwordx4 v[172:175], v14, s[4:7], 0 offen offset:384 nt
    buffer_load_dwordx4 v[176:179], v14, s[8:11], 0 offen nt
    buffer_load_dwordx4 v[180:183], v14, s[8:11], 0 offen offset:128 nt
    buffer_load_dwordx4 v[184:187], v14, s[8:11], 0 offen offset:256 nt
    buffer_load_dwordx4 v[188:191], v14, s[8:11], 0 offen offset:384 nt
    s_mul_i32 s49, s32, 0
    s_add_u32 s49, s49, s26
    s_and_b32 s49, s49, 15
    s_lshl_b32 s47, s32, 4
    s_add_u32 s49, s49, s47
    s_and_b32 s46, s49, 7
    s_lshl_b32 s46, s46, 6
    s_lshr_b32 s47, s49, 3
    s_add_u32 s46, s46, s47
    s_add_u32 s46, s46, s56
    s_and_b32 s46, s46, 511
    s_lshl_b32 s46, s46, 3
    s_add_u32 s46, s46, s55
    s_lshl_b32 s46, s46, 12
    s_add_u32 s46, s46, s29
    v_add_u32 v15, s46, v2
    s_add_u32 s32, s32, 1
    buffer_load_dwordx4 v[192:195], v15, s[4:7], 0 offen nt
    buffer_load_dwordx4 v[196:199], v15, s[4:7], 0 offen offset:128 nt
    buffer_load_dwordx4 v[200:203], v15, s[4:7], 0 offen offset:256 nt
    buffer_load_dwordx4 v[204:207], v15, s[4:7], 0 offen offset:384 nt
    buffer_load_dwordx4 v[208:211], v15, s[8:11], 0 offen nt
    buffer_load_dwordx4 v[212:215], v15, s[8:11], 0 offen offset:128 nt
    buffer_load_dwordx4 v[216:219], v15, s[8:11], 0 offen offset:256 nt
    buffer_load_dwordx4 v[220:223], v15, s[8:11], 0 offen offset:384 nt
    s_mul_i32 s49, s32, 0
    s_add_u32 s49, s49, s26
    s_and_b32 s49, s49, 15
    s_lshl_b32 s47, s32, 4
    s_add_u32 s49, s49, s47
    s_and_b32 s46, s49, 7
    s_lshl_b32 s46, s46, 6
    s_lshr_b32 s47, s49, 3
    s_add_u32 s46, s46, s47
    s_add_u32 s46, s46, s56
    s_and_b32 s46, s46, 511
    s_lshl_b32 s46, s46, 3
    s_add_u32 s46, s46, s55
    s_lshl_b32 s46, s46, 12
    s_add_u32 s46, s46, s29
    v_add_u32 v3, s46, v2
    s_add_u32 s32, s32, 1
    buffer_load_dwordx4 v[64:67], v3, s[4:7], 0 offen nt
    buffer_load_dwordx4 v[68:71], v3, s[4:7], 0 offen offset:128 nt
    buffer_load_dwordx4 v[72:75], v3, s[4:7], 0 offen offset:256 nt
    buffer_load_dwordx4 v[76:79], v3, s[4:7], 0 offen offset:384 nt
    buffer_load_dwordx4 v[80:83], v3, s[8:11], 0 offen nt
    buffer_load_dwordx4 v[84:87], v3, s[8:11], 0 offen offset:128 nt
    buffer_load_dwordx4 v[88:91], v3, s[8:11], 0 offen offset:256 nt
    buffer_load_dwordx4 v[92:95], v3, s[8:11], 0 offen offset:384 nt
L_waitq:
    s_barrier
    v_and_b32 v7, 7, v1
    v_lshlrev_b32 v7, 4, v7
    ds_read_b128 v[16:19], v7 offset:0
    ds_read_b128 v[20:23], v7 offset:128
    ds_read_b128 v[24:27], v7 offset:256
    ds_read_b128 v[28:31], v7 offset:384
    v_mov_b32 v8, 0
    ds_read_b64 v[10:11], v8 offset:512
    v_mov_b32 v32, 0
    v_mov_b32 v33, 0
    v_mov_b32 v34, 0
    v_mov_b32 v35, 0
    v_mov_b32 v36, 0
    v_mov_b32 v37, 0
    v_mov_b32 v38, 0
    v_mov_b32 v39, 0
    v_mov_b32 v40, 0
    v_mov_b32 v41, 0
    v_mov_b32 v42, 0
    v_mov_b32 v43, 0
    v_mov_b32 v44, 0
    v_mov_b32 v45, 0
    v_mov_b32 v46, 0
    v_mov_b32 v47, 0
    v_mov_b32 v48, 0
    v_mov_b32 v49, 0
    v_mov_b32 v50, 0
    v_mov_b32 v51, 0
    v_mov_b32 v52, 0
    v_mov_b32 v53, 0
    v_mov_b32 v54, 0
    v_mov_b32 v55, 0
    v_mov_b32 v56, 0
    v_mov_b32 v57, 0
    v_mov_b32 v58, 0
    v_mov_b32 v59, 0
    v_mov_b32 v60, 0
    v_mov_b32 v61, 0
    v_mov_b32 v62, 0
    v_mov_b32 v63, 0
    v_mov_b32 v4, 0xff61b1e6
    v_mov_b32 v5, 0xff61b1e6
    v_mov_b32 v6, 0
    s_and_b32 s37, s2, 7
    s_lshr_b32 s36, s2, 3
    s_mov_b32 s57, 0
    s_cmp_lt_u32 s2, 224
    s_cselect_b32 s38, 2, 1
    s_cmp_eq_u32 s37, 0
    s_cselect_b32 s35, s38, 0
    s_waitcnt lgkmcnt(0)
    v_readfirstlane_b32 s27, v10
    v_readfirstlane_b32 s28, v11
    s_mov_b32 s34, 0
    s_barrier
    s_waitcnt vmcnt(36)
    v_dot2_f32_bf16 v7, v96, v16, 0
    v_dot2_f32_bf16 v8, v97, v17, 0
    v_dot2_f32_bf16 v9, v98, v18, 0
    v_dot2_f32_bf16 v10, v99, v19, 0
    v_dot2c_f32_bf16 v7, v100, v20
    v_dot2c_f32_bf16 v8, v101, v21
    v_dot2c_f32_bf16 v9, v102, v22
    v_dot2c_f32_bf16 v10, v103, v23
    v_dot2c_f32_bf16 v7, v104, v24
    v_dot2c_f32_bf16 v8, v105, v25
    v_dot2c_f32_bf16 v9, v106, v26
    v_dot2c_f32_bf16 v10, v107, v27
    v_dot2c_f32_bf16 v7, v108, v28
    v_dot2c_f32_bf16 v8, v109, v29
    v_dot2c_f32_bf16 v9, v110, v30
    v_dot2c_f32_bf16 v10, v111, v31
    s_mul_i32 s49, s32, 0
    s_add_u32 s49, s49, s26
    s_and_b32 s49, s49, 15
    s_lshl_b32 s47, s32, 4
    s_add_u32 s49, s49, s47
    s_and_b32 s46, s49, 7
    s_lshl_b32 s46, s46, 6
    s_lshr_b32 s47, s49, 3
    s_add_u32 s46, s46, s47
    s_add_u32 s46, s46, s56
    s_and_b32 s46, s46, 511
    s_lshl_b32 s46, s46, 3
    s_add_u32 s46, s46, s55
    s_lshl_b32 s46, s46, 12
    s_add_u32 s46, s46, s29
    v_add_u32 v12, s46, v2
    s_add_u32 s32, s32, 1
    buffer_load_dwordx4 v[96:99], v12, s[4:7], 0 offen nt
    buffer_load_dwordx4 v[100:103], v12, s[4:7], 0 offen offset:128 nt
    buffer_load_dwordx4 v[104:107], v12, s[4:7], 0 offen offset:256 nt
    buffer_load_dwordx4 v[108:111], v12, s[4:7], 0 offen offset:384 nt
    v_add_f32 v7, v7, v8
    v_add_f32 v9, v9, v10
    v_add_f32 v7, v7, v9
    s_nop 1
    v_add_f32_dpp v7, v7, v7 quad_perm:[1,0,3,2] row_mask:0xf bank_mask:0xf
    s_nop 1
    v_add_f32_dpp v7, v7, v7 quad_perm:[2,3,0,1] row_mask:0xf bank_mask:0xf
    s_nop 1
    v_add_f32_dpp v7, v7, v7 row_half_mirror row_mask:0xf bank_mask:0xf
    s_nop 1
    v_cvt_pk_bf16_f32 v8, v7, v7
    v_lshlrev_b32 v7, 16, v8
    v_cmp_gt_f32 vcc, v7, v4
    s_cbranch_vccnz L_resc_3
L_cont_4:
    v_fma_f32 v8, v7, s33, -v5
    v_exp_f32 v8, v8
    s_nop 0
    v_add_f32 v6, v6, v8
    v_cvt_pk_bf16_f32 v9, v8, 0
    v_cvt_pk_bf16_f32 v10, 0, v8
    s_waitcnt vmcnt(36)
    v_dot2c_f32_bf16 v32, v112, v9
    v_dot2c_f32_bf16 v33, v112, v10
    v_dot2c_f32_bf16 v34, v113, v9
    v_dot2c_f32_bf16 v35, v113, v10
    v_dot2c_f32_bf16 v36, v114, v9
    v_dot2c_f32_bf16 v37, v114, v10
    v_dot2c_f32_bf16 v38, v115, v9
    v_dot2c_f32_bf16 v39, v115, v10
    v_dot2c_f32_bf16 v40, v116, v9
    v_dot2c_f32_bf16 v41, v116, v10
    v_dot2c_f32_bf16 v42, v117, v9
    v_dot2c_f32_bf16 v43, v117, v10
    v_dot2c_f32_bf16 v44, v118, v9
    v_dot2c_f32_bf16 v45, v118, v10
    v_dot2c_f32_bf16 v46, v119, v9
    v_dot2c_f32_bf16 v47, v119, v10
    v_dot2c_f32_bf16 v48, v120, v9
    v_dot2c_f32_bf16 v49, v120, v10
    v_dot2c_f32_bf16 v50, v121, v9
    v_dot2c_f32_bf16 v51, v121, v10
    v_dot2c_f32_bf16 v52, v122, v9
    v_dot2c_f32_bf16 v53, v122, v10
    v_dot2c_f32_bf16 v54, v123, v9
    v_dot2c_f32_bf16 v55, v123, v10
    v_dot2c_f32_bf16 v56, v124, v9
    v_dot2c_f32_bf16 v57, v124, v10
    v_dot2c_f32_bf16 v58, v125, v9
    v_dot2c_f32_bf16 v59, v125, v10
    v_dot2c_f32_bf16 v60, v126, v9
    v_dot2c_f32_bf16 v61, v126, v10
    v_dot2c_f32_bf16 v62, v127, v9
    v_dot2c_f32_bf16 v63, v127, v10
    buffer_load_dwordx4 v[112:115], v12, s[8:11], 0 offen nt
    buffer_load_dwordx4 v[116:119], v12, s[8:11], 0 offen offset:128 nt
    buffer_load_dwordx4 v[120:123], v12, s[8:11], 0 offen offset:256 nt
    buffer_load_dwordx4 v[124:127], v12, s[8:11], 0 offen offset:384 nt
    s_barrier
    s_waitcnt vmcnt(36)
    v_dot2_f32_bf16 v7, v128, v16, 0
    v_dot2_f32_bf16 v8, v129, v17, 0
    v_dot2_f32_bf16 v9, v130, v18, 0
    v_dot2_f32_bf16 v10, v131, v19, 0
    v_dot2c_f32_bf16 v7, v132, v20
    v_dot2c_f32_bf16 v8, v133, v21
    v_dot2c_f32_bf16 v9, v134, v22
    v_dot2c_f32_bf16 v10, v135, v23
    v_dot2c_f32_bf16 v7, v136, v24
    v_dot2c_f32_bf16 v8, v137, v25
    v_dot2c_f32_bf16 v9, v138, v26
    v_dot2c_f32_bf16 v10, v139, v27
    v_dot2c_f32_bf16 v7, v140, v28
    v_dot2c_f32_bf16 v8, v141, v29
    v_dot2c_f32_bf16 v9, v142, v30
    v_dot2c_f32_bf16 v10, v143, v31
    s_mul_i32 s49, s32, 0
    s_add_u32 s49, s49, s26
    s_and_b32 s49, s49, 15
    s_lshl_b32 s47, s32, 4
    s_add_u32 s49, s49, s47
    s_and_b32 s46, s49, 7
    s_lshl_b32 s46, s46, 6
    s_lshr_b32 s47, s49, 3
    s_add_u32 s46, s46, s47
    s_add_u32 s46, s46, s56
    s_and_b32 s46, s46, 511
    s_lshl_b32 s46, s46, 3
    s_add_u32 s46, s46, s55
    s_lshl_b32 s46, s46, 12
    s_add_u32 s46, s46, s29
    v_add_u32 v13, s46, v2
    s_add_u32 s32, s32, 1
    buffer_load_dwordx4 v[128:131], v13, s[4:7], 0 offen nt
    buffer_load_dwordx4 v[132:135], v13, s[4:7], 0 offen offset:128 nt
    buffer_load_dwordx4 v[136:139], v13, s[4:7], 0 offen offset:256 nt
    buffer_load_dwordx4 v[140:143], v13, s[4:7], 0 offen offset:384 nt
    v_add_f32 v7, v7, v8
    v_add_f32 v9, v9, v10
    v_add_f32 v7, v7, v9
    s_nop 1
    v_add_f32_dpp v7, v7, v7 quad_perm:[1,0,3,2] row_mask:0xf bank_mask:0xf
    s_nop 1
    v_add_f32_dpp v7, v7, v7 quad_perm:[2,3,0,1] row_mask:0xf bank_mask:0xf
    s_nop 1
    v_add_f32_dpp v7, v7, v7 row_half_mirror row_mask:0xf bank_mask:0xf
    s_nop 1
    v_cvt_pk_bf16_f32 v8, v7, v7
    v_lshlrev_b32 v7, 16, v8
    v_cmp_gt_f32 vcc, v7, v4
    s_cbranch_vccnz L_resc_5
L_cont_6:
    v_fma_f32 v8, v7, s33, -v5
    v_exp_f32 v8, v8
    s_nop 0
    v_add_f32 v6, v6, v8
    v_cvt_pk_bf16_f32 v9, v8, 0
    v_cvt_pk_bf16_f32 v10, 0, v8
    s_waitcnt vmcnt(36)
    v_dot2c_f32_bf16 v32, v144, v9
    v_dot2c_f32_bf16 v33, v144, v10
    v_dot2c_f32_bf16 v34, v145, v9
    v_dot2c_f32_bf16 v35, v145, v10
    v_dot2c_f32_bf16 v36, v146, v9
    v_dot2c_f32_bf16 v37, v146, v10
    v_dot2c_f32_bf16 v38, v147, v9
    v_dot2c_f32_bf16 v39, v147, v10
    v_dot2c_f32_bf16 v40, v148, v9
    v_dot2c_f32_bf16 v41, v148, v10
    v_dot2c_f32_bf16 v42, v149, v9
    v_dot2c_f32_bf16 v43, v149, v10
    v_dot2c_f32_bf16 v44, v150, v9
    v_dot2c_f32_bf16 v45, v150, v10
    v_dot2c_f32_bf16 v46, v151, v9
    v_dot2c_f32_bf16 v47, v151, v10
    v_dot2c_f32_bf16 v48, v152, v9
    v_dot2c_f32_bf16 v49, v152, v10
    v_dot2c_f32_bf16 v50, v153, v9
    v_dot2c_f32_bf16 v51, v153, v10
    v_dot2c_f32_bf16 v52, v154, v9
    v_dot2c_f32_bf16 v53, v154, v10
    v_dot2c_f32_bf16 v54, v155, v9
    v_dot2c_f32_bf16 v55, v155, v10
    v_dot2c_f32_bf16 v56, v156, v9
    v_dot2c_f32_bf16 v57, v156, v10
    v_dot2c_f32_bf16 v58, v157, v9
    v_dot2c_f32_bf16 v59, v157, v10
    v_dot2c_f32_bf16 v60, v158, v9
    v_dot2c_f32_bf16 v61, v158, v10
    v_dot2c_f32_bf16 v62, v159, v9
    v_dot2c_f32_bf16 v63, v159, v10
    buffer_load_dwordx4 v[144:147], v13, s[8:11], 0 offen nt
    buffer_load_dwordx4 v[148:151], v13, s[8:11], 0 offen offset:128 nt
    buffer_load_dwordx4 v[152:155], v13, s[8:11], 0 offen offset:256 nt
    buffer_load_dwordx4 v[156:159], v13, s[8:11], 0 offen offset:384 nt
    s_barrier
    s_waitcnt vmcnt(36)
    v_dot2_f32_bf16 v7, v160, v16, 0
    v_dot2_f32_bf16 v8, v161, v17, 0
    v_dot2_f32_bf16 v9, v162, v18, 0
    v_dot2_f32_bf16 v10, v163, v19, 0
    v_dot2c_f32_bf16 v7, v164, v20
    v_dot2c_f32_bf16 v8, v165, v21
    v_dot2c_f32_bf16 v9, v166, v22
    v_dot2c_f32_bf16 v10, v167, v23
    v_dot2c_f32_bf16 v7, v168, v24
    v_dot2c_f32_bf16 v8, v169, v25
    v_dot2c_f32_bf16 v9, v170, v26
    v_dot2c_f32_bf16 v10, v171, v27
    v_dot2c_f32_bf16 v7, v172, v28
    v_dot2c_f32_bf16 v8, v173, v29
    v_dot2c_f32_bf16 v9, v174, v30
    v_dot2c_f32_bf16 v10, v175, v31
    s_mul_i32 s49, s32, 0
    s_add_u32 s49, s49, s26
    s_and_b32 s49, s49, 15
    s_lshl_b32 s47, s32, 4
    s_add_u32 s49, s49, s47
    s_and_b32 s46, s49, 7
    s_lshl_b32 s46, s46, 6
    s_lshr_b32 s47, s49, 3
    s_add_u32 s46, s46, s47
    s_add_u32 s46, s46, s56
    s_and_b32 s46, s46, 511
    s_lshl_b32 s46, s46, 3
    s_add_u32 s46, s46, s55
    s_lshl_b32 s46, s46, 12
    s_add_u32 s46, s46, s29
    v_add_u32 v14, s46, v2
    s_add_u32 s32, s32, 1
    buffer_load_dwordx4 v[160:163], v14, s[4:7], 0 offen nt
    buffer_load_dwordx4 v[164:167], v14, s[4:7], 0 offen offset:128 nt
    buffer_load_dwordx4 v[168:171], v14, s[4:7], 0 offen offset:256 nt
    buffer_load_dwordx4 v[172:175], v14, s[4:7], 0 offen offset:384 nt
    v_add_f32 v7, v7, v8
    v_add_f32 v9, v9, v10
    v_add_f32 v7, v7, v9
    s_nop 1
    v_add_f32_dpp v7, v7, v7 quad_perm:[1,0,3,2] row_mask:0xf bank_mask:0xf
    s_nop 1
    v_add_f32_dpp v7, v7, v7 quad_perm:[2,3,0,1] row_mask:0xf bank_mask:0xf
    s_nop 1
    v_add_f32_dpp v7, v7, v7 row_half_mirror row_mask:0xf bank_mask:0xf
    s_nop 1
    v_cvt_pk_bf16_f32 v8, v7, v7
    v_lshlrev_b32 v7, 16, v8
    v_cmp_gt_f32 vcc, v7, v4
    s_cbranch_vccnz L_resc_7
L_cont_8:
    v_fma_f32 v8, v7, s33, -v5
    v_exp_f32 v8, v8
    s_nop 0
    v_add_f32 v6, v6, v8
    v_cvt_pk_bf16_f32 v9, v8, 0
    v_cvt_pk_bf16_f32 v10, 0, v8
    s_waitcnt vmcnt(36)
    v_dot2c_f32_bf16 v32, v176, v9
    v_dot2c_f32_bf16 v33, v176, v10
    v_dot2c_f32_bf16 v34, v177, v9
    v_dot2c_f32_bf16 v35, v177, v10
    v_dot2c_f32_bf16 v36, v178, v9
    v_dot2c_f32_bf16 v37, v178, v10
    v_dot2c_f32_bf16 v38, v179, v9
    v_dot2c_f32_bf16 v39, v179, v10
    v_dot2c_f32_bf16 v40, v180, v9
    v_dot2c_f32_bf16 v41, v180, v10
    v_dot2c_f32_bf16 v42, v181, v9
    v_dot2c_f32_bf16 v43, v181, v10
    v_dot2c_f32_bf16 v44, v182, v9
    v_dot2c_f32_bf16 v45, v182, v10
    v_dot2c_f32_bf16 v46, v183, v9
    v_dot2c_f32_bf16 v47, v183, v10
    v_dot2c_f32_bf16 v48, v184, v9
    v_dot2c_f32_bf16 v49, v184, v10
    v_dot2c_f32_bf16 v50, v185, v9
    v_dot2c_f32_bf16 v51, v185, v10
    v_dot2c_f32_bf16 v52, v186, v9
    v_dot2c_f32_bf16 v53, v186, v10
    v_dot2c_f32_bf16 v54, v187, v9
    v_dot2c_f32_bf16 v55, v187, v10
    v_dot2c_f32_bf16 v56, v188, v9
    v_dot2c_f32_bf16 v57, v188, v10
    v_dot2c_f32_bf16 v58, v189, v9
    v_dot2c_f32_bf16 v59, v189, v10
    v_dot2c_f32_bf16 v60, v190, v9
    v_dot2c_f32_bf16 v61, v190, v10
    v_dot2c_f32_bf16 v62, v191, v9
    v_dot2c_f32_bf16 v63, v191, v10
    buffer_load_dwordx4 v[176:179], v14, s[8:11], 0 offen nt
    buffer_load_dwordx4 v[180:183], v14, s[8:11], 0 offen offset:128 nt
    buffer_load_dwordx4 v[184:187], v14, s[8:11], 0 offen offset:256 nt
    buffer_load_dwordx4 v[188:191], v14, s[8:11], 0 offen offset:384 nt
    s_barrier
    s_waitcnt vmcnt(36)
    v_dot2_f32_bf16 v7, v192, v16, 0
    v_dot2_f32_bf16 v8, v193, v17, 0
    v_dot2_f32_bf16 v9, v194, v18, 0
    v_dot2_f32_bf16 v10, v195, v19, 0
    v_dot2c_f32_bf16 v7, v196, v20
    v_dot2c_f32_bf16 v8, v197, v21
    v_dot2c_f32_bf16 v9, v198, v22
    v_dot2c_f32_bf16 v10, v199, v23
    v_dot2c_f32_bf16 v7, v200, v24
    v_dot2c_f32_bf16 v8, v201, v25
    v_dot2c_f32_bf16 v9, v202, v26
    v_dot2c_f32_bf16 v10, v203, v27
    v_dot2c_f32_bf16 v7, v204, v28
    v_dot2c_f32_bf16 v8, v205, v29
    v_dot2c_f32_bf16 v9, v206, v30
    v_dot2c_f32_bf16 v10, v207, v31
    s_mul_i32 s49, s32, 0
    s_add_u32 s49, s49, s26
    s_and_b32 s49, s49, 15
    s_lshl_b32 s47, s32, 4
    s_add_u32 s49, s49, s47
    s_and_b32 s46, s49, 7
    s_lshl_b32 s46, s46, 6
    s_lshr_b32 s47, s49, 3
    s_add_u32 s46, s46, s47
    s_add_u32 s46, s46, s56
    s_and_b32 s46, s46, 511
    s_lshl_b32 s46, s46, 3
    s_add_u32 s46, s46, s55
    s_lshl_b32 s46, s46, 12
    s_add_u32 s46, s46, s29
    v_add_u32 v15, s46, v2
    s_add_u32 s32, s32, 1
    buffer_load_dwordx4 v[192:195], v15, s[4:7], 0 offen nt
    buffer_load_dwordx4 v[196:199], v15, s[4:7], 0 offen offset:128 nt
    buffer_load_dwordx4 v[200:203], v15, s[4:7], 0 offen offset:256 nt
    buffer_load_dwordx4 v[204:207], v15, s[4:7], 0 offen offset:384 nt
    v_add_f32 v7, v7, v8
    v_add_f32 v9, v9, v10
    v_add_f32 v7, v7, v9
    s_nop 1
    v_add_f32_dpp v7, v7, v7 quad_perm:[1,0,3,2] row_mask:0xf bank_mask:0xf
    s_nop 1
    v_add_f32_dpp v7, v7, v7 quad_perm:[2,3,0,1] row_mask:0xf bank_mask:0xf
    s_nop 1
    v_add_f32_dpp v7, v7, v7 row_half_mirror row_mask:0xf bank_mask:0xf
    s_nop 1
    v_cvt_pk_bf16_f32 v8, v7, v7
    v_lshlrev_b32 v7, 16, v8
    v_cmp_gt_f32 vcc, v7, v4
    s_cbranch_vccnz L_resc_9
L_cont_10:
    v_fma_f32 v8, v7, s33, -v5
    v_exp_f32 v8, v8
    s_nop 0
    v_add_f32 v6, v6, v8
    v_cvt_pk_bf16_f32 v9, v8, 0
    v_cvt_pk_bf16_f32 v10, 0, v8
    s_waitcnt vmcnt(36)
    v_dot2c_f32_bf16 v32, v208, v9
    v_dot2c_f32_bf16 v33, v208, v10
    v_dot2c_f32_bf16 v34, v209, v9
    v_dot2c_f32_bf16 v35, v209, v10
    v_dot2c_f32_bf16 v36, v210, v9
    v_dot2c_f32_bf16 v37, v210, v10
    v_dot2c_f32_bf16 v38, v211, v9
    v_dot2c_f32_bf16 v39, v211, v10
    v_dot2c_f32_bf16 v40, v212, v9
    v_dot2c_f32_bf16 v41, v212, v10
    v_dot2c_f32_bf16 v42, v213, v9
    v_dot2c_f32_bf16 v43, v213, v10
    v_dot2c_f32_bf16 v44, v214, v9
    v_dot2c_f32_bf16 v45, v214, v10
    v_dot2c_f32_bf16 v46, v215, v9
    v_dot2c_f32_bf16 v47, v215, v10
    v_dot2c_f32_bf16 v48, v216, v9
    v_dot2c_f32_bf16 v49, v216, v10
    v_dot2c_f32_bf16 v50, v217, v9
    v_dot2c_f32_bf16 v51, v217, v10
    v_dot2c_f32_bf16 v52, v218, v9
    v_dot2c_f32_bf16 v53, v218, v10
    v_dot2c_f32_bf16 v54, v219, v9
    v_dot2c_f32_bf16 v55, v219, v10
    v_dot2c_f32_bf16 v56, v220, v9
    v_dot2c_f32_bf16 v57, v220, v10
    v_dot2c_f32_bf16 v58, v221, v9
    v_dot2c_f32_bf16 v59, v221, v10
    v_dot2c_f32_bf16 v60, v222, v9
    v_dot2c_f32_bf16 v61, v222, v10
    v_dot2c_f32_bf16 v62, v223, v9
    v_dot2c_f32_bf16 v63, v223, v10
    buffer_load_dwordx4 v[208:211], v15, s[8:11], 0 offen nt
    buffer_load_dwordx4 v[212:215], v15, s[8:11], 0 offen offset:128 nt
    buffer_load_dwordx4 v[216:219], v15, s[8:11], 0 offen offset:256 nt
    buffer_load_dwordx4 v[220:223], v15, s[8:11], 0 offen offset:384 nt
    s_barrier
    s_waitcnt vmcnt(36)
    v_dot2_f32_bf16 v7, v64, v16, 0
    v_dot2_f32_bf16 v8, v65, v17, 0
    v_dot2_f32_bf16 v9, v66, v18, 0
    v_dot2_f32_bf16 v10, v67, v19, 0
    v_dot2c_f32_bf16 v7, v68, v20
    v_dot2c_f32_bf16 v8, v69, v21
    v_dot2c_f32_bf16 v9, v70, v22
    v_dot2c_f32_bf16 v10, v71, v23
    v_dot2c_f32_bf16 v7, v72, v24
    v_dot2c_f32_bf16 v8, v73, v25
    v_dot2c_f32_bf16 v9, v74, v26
    v_dot2c_f32_bf16 v10, v75, v27
    v_dot2c_f32_bf16 v7, v76, v28
    v_dot2c_f32_bf16 v8, v77, v29
    v_dot2c_f32_bf16 v9, v78, v30
    v_dot2c_f32_bf16 v10, v79, v31
    s_nop 2
    v_add_f32 v7, v7, v8
    v_add_f32 v9, v9, v10
    v_add_f32 v7, v7, v9
    s_nop 1
    v_add_f32_dpp v7, v7, v7 quad_perm:[1,0,3,2] row_mask:0xf bank_mask:0xf
    s_nop 1
    v_add_f32_dpp v7, v7, v7 quad_perm:[2,3,0,1] row_mask:0xf bank_mask:0xf
    s_nop 1
    v_add_f32_dpp v7, v7, v7 row_half_mirror row_mask:0xf bank_mask:0xf
    s_nop 1
    v_cvt_pk_bf16_f32 v8, v7, v7
    v_lshlrev_b32 v7, 16, v8
    v_cmp_gt_f32 vcc, v7, v4
    s_cbranch_vccnz L_resc_11
L_cont_12:
    v_fma_f32 v8, v7, s33, -v5
    v_exp_f32 v8, v8
    s_nop 0
    v_add_f32 v6, v6, v8
    v_cvt_pk_bf16_f32 v9, v8, 0
    v_cvt_pk_bf16_f32 v10, 0, v8
    s_waitcnt vmcnt(32)
    v_dot2c_f32_bf16 v32, v80, v9
    v_dot2c_f32_bf16 v33, v80, v10
    v_dot2c_f32_bf16 v34, v81, v9
    v_dot2c_f32_bf16 v35, v81, v10
    v_dot2c_f32_bf16 v36, v82, v9
    v_dot2c_f32_bf16 v37, v82, v10
    v_dot2c_f32_bf16 v38, v83, v9
    v_dot2c_f32_bf16 v39, v83, v10
    v_dot2c_f32_bf16 v40, v84, v9
    v_dot2c_f32_bf16 v41, v84, v10
    v_dot2c_f32_bf16 v42, v85, v9
    v_dot2c_f32_bf16 v43, v85, v10
    v_dot2c_f32_bf16 v44, v86, v9
    v_dot2c_f32_bf16 v45, v86, v10
    v_dot2c_f32_bf16 v46, v87, v9
    v_dot2c_f32_bf16 v47, v87, v10
    v_dot2c_f32_bf16 v48, v88, v9
    v_dot2c_f32_bf16 v49, v88, v10
    v_dot2c_f32_bf16 v50, v89, v9
    v_dot2c_f32_bf16 v51, v89, v10
    v_dot2c_f32_bf16 v52, v90, v9
    v_dot2c_f32_bf16 v53, v90, v10
    v_dot2c_f32_bf16 v54, v91, v9
    v_dot2c_f32_bf16 v55, v91, v10
    v_dot2c_f32_bf16 v56, v92, v9
    v_dot2c_f32_bf16 v57, v92, v10
    v_dot2c_f32_bf16 v58, v93, v9
    v_dot2c_f32_bf16 v59, v93, v10
    v_dot2c_f32_bf16 v60, v94, v9
    v_dot2c_f32_bf16 v61, v94, v10
    v_dot2c_f32_bf16 v62, v95, v9
    v_dot2c_f32_bf16 v63, v95, v10
L_loop:
    s_barrier
    s_waitcnt vmcnt(28)
    v_dot2_f32_bf16 v7, v96, v16, 0
    v_dot2_f32_bf16 v8, v97, v17, 0
    v_dot2_f32_bf16 v9, v98, v18, 0
    v_dot2_f32_bf16 v10, v99, v19, 0
    v_dot2c_f32_bf16 v7, v100, v20
    v_dot2c_f32_bf16 v8, v101, v21
    v_dot2c_f32_bf16 v9, v102, v22
    v_dot2c_f32_bf16 v10, v103, v23
    v_dot2c_f32_bf16 v7, v104, v24
    v_dot2c_f32_bf16 v8, v105, v25
    v_dot2c_f32_bf16 v9, v106, v26
    v_dot2c_f32_bf16 v10, v107, v27
    v_dot2c_f32_bf16 v7, v108, v28
    v_dot2c_f32_bf16 v8, v109, v29
    v_dot2c_f32_bf16 v9, v110, v30
    v_dot2c_f32_bf16 v10, v111, v31
    s_mul_i32 s49, s32, 0
    s_add_u32 s49, s49, s26
    s_and_b32 s49, s49, 15
    s_lshl_b32 s47, s32, 4
    s_add_u32 s49, s49, s47
    s_and_b32 s46, s49, 7
    s_lshl_b32 s46, s46, 6
    s_lshr_b32 s47, s49, 3
    s_add_u32 s46, s46, s47
    s_add_u32 s46, s46, s56
    s_and_b32 s46, s46, 511
    s_lshl_b32 s46, s46, 3
    s_add_u32 s46, s46, s55
    s_lshl_b32 s46, s46, 12
    s_add_u32 s46, s46, s29
    v_add_u32 v12, s46, v2
    s_add_u32 s32, s32, 1
    buffer_load_dwordx4 v[96:99], v12, s[4:7], 0 offen nt
    buffer_load_dwordx4 v[100:103], v12, s[4:7], 0 offen offset:128 nt
    buffer_load_dwordx4 v[104:107], v12, s[4:7], 0 offen offset:256 nt
    buffer_load_dwordx4 v[108:111], v12, s[4:7], 0 offen offset:384 nt
    v_add_f32 v7, v7, v8
    v_add_f32 v9, v9, v10
    v_add_f32 v7, v7, v9
    s_nop 1
    v_add_f32_dpp v7, v7, v7 quad_perm:[1,0,3,2] row_mask:0xf bank_mask:0xf
    s_nop 1
    v_add_f32_dpp v7, v7, v7 quad_perm:[2,3,0,1] row_mask:0xf bank_mask:0xf
    s_nop 1
    v_add_f32_dpp v7, v7, v7 row_half_mirror row_mask:0xf bank_mask:0xf
    s_nop 1
    v_cvt_pk_bf16_f32 v8, v7, v7
    v_lshlrev_b32 v7, 16, v8
    v_cmp_gt_f32 vcc, v7, v4
    s_cbranch_vccnz L_resc_13
L_cont_14:
    v_fma_f32 v8, v7, s33, -v5
    v_exp_f32 v8, v8
    s_nop 0
    v_add_f32 v6, v6, v8
    v_cvt_pk_bf16_f32 v9, v8, 0
    v_cvt_pk_bf16_f32 v10, 0, v8
    s_waitcnt vmcnt(28)
    v_dot2c_f32_bf16 v32, v112, v9
    v_dot2c_f32_bf16 v33, v112, v10
    v_dot2c_f32_bf16 v34, v113, v9
    v_dot2c_f32_bf16 v35, v113, v10
    v_dot2c_f32_bf16 v36, v114, v9
    v_dot2c_f32_bf16 v37, v114, v10
    v_dot2c_f32_bf16 v38, v115, v9
    v_dot2c_f32_bf16 v39, v115, v10
    v_dot2c_f32_bf16 v40, v116, v9
    v_dot2c_f32_bf16 v41, v116, v10
    v_dot2c_f32_bf16 v42, v117, v9
    v_dot2c_f32_bf16 v43, v117, v10
    v_dot2c_f32_bf16 v44, v118, v9
    v_dot2c_f32_bf16 v45, v118, v10
    v_dot2c_f32_bf16 v46, v119, v9
    v_dot2c_f32_bf16 v47, v119, v10
    v_dot2c_f32_bf16 v48, v120, v9
    v_dot2c_f32_bf16 v49, v120, v10
    v_dot2c_f32_bf16 v50, v121, v9
    v_dot2c_f32_bf16 v51, v121, v10
    v_dot2c_f32_bf16 v52, v122, v9
    v_dot2c_f32_bf16 v53, v122, v10
    v_dot2c_f32_bf16 v54, v123, v9
    v_dot2c_f32_bf16 v55, v123, v10
    v_dot2c_f32_bf16 v56, v124, v9
    v_dot2c_f32_bf16 v57, v124, v10
    v_dot2c_f32_bf16 v58, v125, v9
    v_dot2c_f32_bf16 v59, v125, v10
    v_dot2c_f32_bf16 v60, v126, v9
    v_dot2c_f32_bf16 v61, v126, v10
    v_dot2c_f32_bf16 v62, v127, v9
    v_dot2c_f32_bf16 v63, v127, v10
    buffer_load_dwordx4 v[112:115], v12, s[8:11], 0 offen nt
    buffer_load_dwordx4 v[116:119], v12, s[8:11], 0 offen offset:128 nt
    buffer_load_dwordx4 v[120:123], v12, s[8:11], 0 offen offset:256 nt
    buffer_load_dwordx4 v[124:127], v12, s[8:11], 0 offen offset:384 nt
    s_barrier
    s_waitcnt vmcnt(28)
    v_dot2_f32_bf16 v7, v128, v16, 0
    v_dot2_f32_bf16 v8, v129, v17, 0
    v_dot2_f32_bf16 v9, v130, v18, 0
    v_dot2_f32_bf16 v10, v131, v19, 0
    v_dot2c_f32_bf16 v7, v132, v20
    v_dot2c_f32_bf16 v8, v133, v21
    v_dot2c_f32_bf16 v9, v134, v22
    v_dot2c_f32_bf16 v10, v135, v23
    v_dot2c_f32_bf16 v7, v136, v24
    v_dot2c_f32_bf16 v8, v137, v25
    v_dot2c_f32_bf16 v9, v138, v26
    v_dot2c_f32_bf16 v10, v139, v27
    v_dot2c_f32_bf16 v7, v140, v28
    v_dot2c_f32_bf16 v8, v141, v29
    v_dot2c_f32_bf16 v9, v142, v30
    v_dot2c_f32_bf16 v10, v143, v31
    s_mul_i32 s49, s32, 0
    s_add_u32 s49, s49, s26
    s_and_b32 s49, s49, 15
    s_lshl_b32 s47, s32, 4
    s_add_u32 s49, s49, s47
    s_and_b32 s46, s49, 7
    s_lshl_b32 s46, s46, 6
    s_lshr_b32 s47, s49, 3
    s_add_u32 s46, s46, s47
    s_add_u32 s46, s46, s56
    s_and_b32 s46, s46, 511
    s_lshl_b32 s46, s46, 3
    s_add_u32 s46, s46, s55
    s_lshl_b32 s46, s46, 12
    s_add_u32 s46, s46, s29
    v_add_u32 v13, s46, v2
    s_add_u32 s32, s32, 1
    buffer_load_dwordx4 v[128:131], v13, s[4:7], 0 offen nt
    buffer_load_dwordx4 v[132:135], v13, s[4:7], 0 offen offset:128 nt
    buffer_load_dwordx4 v[136:139], v13, s[4:7], 0 offen offset:256 nt
    buffer_load_dwordx4 v[140:143], v13, s[4:7], 0 offen offset:384 nt
    v_add_f32 v7, v7, v8
    v_add_f32 v9, v9, v10
    v_add_f32 v7, v7, v9
    s_nop 1
    v_add_f32_dpp v7, v7, v7 quad_perm:[1,0,3,2] row_mask:0xf bank_mask:0xf
    s_nop 1
    v_add_f32_dpp v7, v7, v7 quad_perm:[2,3,0,1] row_mask:0xf bank_mask:0xf
    s_nop 1
    v_add_f32_dpp v7, v7, v7 row_half_mirror row_mask:0xf bank_mask:0xf
    s_nop 1
    v_cvt_pk_bf16_f32 v8, v7, v7
    v_lshlrev_b32 v7, 16, v8
    v_cmp_gt_f32 vcc, v7, v4
    s_cbranch_vccnz L_resc_15
L_cont_16:
    v_fma_f32 v8, v7, s33, -v5
    v_exp_f32 v8, v8
    s_nop 0
    v_add_f32 v6, v6, v8
    v_cvt_pk_bf16_f32 v9, v8, 0
    v_cvt_pk_bf16_f32 v10, 0, v8
    s_waitcnt vmcnt(28)
    v_dot2c_f32_bf16 v32, v144, v9
    v_dot2c_f32_bf16 v33, v144, v10
    v_dot2c_f32_bf16 v34, v145, v9
    v_dot2c_f32_bf16 v35, v145, v10
    v_dot2c_f32_bf16 v36, v146, v9
    v_dot2c_f32_bf16 v37, v146, v10
    v_dot2c_f32_bf16 v38, v147, v9
    v_dot2c_f32_bf16 v39, v147, v10
    v_dot2c_f32_bf16 v40, v148, v9
    v_dot2c_f32_bf16 v41, v148, v10
    v_dot2c_f32_bf16 v42, v149, v9
    v_dot2c_f32_bf16 v43, v149, v10
    v_dot2c_f32_bf16 v44, v150, v9
    v_dot2c_f32_bf16 v45, v150, v10
    v_dot2c_f32_bf16 v46, v151, v9
    v_dot2c_f32_bf16 v47, v151, v10
    v_dot2c_f32_bf16 v48, v152, v9
    v_dot2c_f32_bf16 v49, v152, v10
    v_dot2c_f32_bf16 v50, v153, v9
    v_dot2c_f32_bf16 v51, v153, v10
    v_dot2c_f32_bf16 v52, v154, v9
    v_dot2c_f32_bf16 v53, v154, v10
    v_dot2c_f32_bf16 v54, v155, v9
    v_dot2c_f32_bf16 v55, v155, v10
    v_dot2c_f32_bf16 v56, v156, v9
    v_dot2c_f32_bf16 v57, v156, v10
    v_dot2c_f32_bf16 v58, v157, v9
    v_dot2c_f32_bf16 v59, v157, v10
    v_dot2c_f32_bf16 v60, v158, v9
    v_dot2c_f32_bf16 v61, v158, v10
    v_dot2c_f32_bf16 v62, v159, v9
    v_dot2c_f32_bf16 v63, v159, v10
    buffer_load_dwordx4 v[144:147], v13, s[8:11], 0 offen nt
    buffer_load_dwordx4 v[148:151], v13, s[8:11], 0 offen offset:128 nt
    buffer_load_dwordx4 v[152:155], v13, s[8:11], 0 offen offset:256 nt
    buffer_load_dwordx4 v[156:159], v13, s[8:11], 0 offen offset:384 nt
    s_barrier
    s_waitcnt vmcnt(28)
    v_dot2_f32_bf16 v7, v160, v16, 0
    v_dot2_f32_bf16 v8, v161, v17, 0
    v_dot2_f32_bf16 v9, v162, v18, 0
    v_dot2_f32_bf16 v10, v163, v19, 0
    v_dot2c_f32_bf16 v7, v164, v20
    v_dot2c_f32_bf16 v8, v165, v21
    v_dot2c_f32_bf16 v9, v166, v22
    v_dot2c_f32_bf16 v10, v167, v23
    v_dot2c_f32_bf16 v7, v168, v24
    v_dot2c_f32_bf16 v8, v169, v25
    v_dot2c_f32_bf16 v9, v170, v26
    v_dot2c_f32_bf16 v10, v171, v27
    v_dot2c_f32_bf16 v7, v172, v28
    v_dot2c_f32_bf16 v8, v173, v29
    v_dot2c_f32_bf16 v9, v174, v30
    v_dot2c_f32_bf16 v10, v175, v31
    s_mul_i32 s49, s32, 0
    s_add_u32 s49, s49, s26
    s_and_b32 s49, s49, 15
    s_lshl_b32 s47, s32, 4
    s_add_u32 s49, s49, s47
    s_and_b32 s46, s49, 7
    s_lshl_b32 s46, s46, 6
    s_lshr_b32 s47, s49, 3
    s_add_u32 s46, s46, s47
    s_add_u32 s46, s46, s56
    s_and_b32 s46, s46, 511
    s_lshl_b32 s46, s46, 3
    s_add_u32 s46, s46, s55
    s_lshl_b32 s46, s46, 12
    s_add_u32 s46, s46, s29
    v_add_u32 v14, s46, v2
    s_add_u32 s32, s32, 1
    buffer_load_dwordx4 v[160:163], v14, s[4:7], 0 offen nt
    buffer_load_dwordx4 v[164:167], v14, s[4:7], 0 offen offset:128 nt
    buffer_load_dwordx4 v[168:171], v14, s[4:7], 0 offen offset:256 nt
    buffer_load_dwordx4 v[172:175], v14, s[4:7], 0 offen offset:384 nt
    v_add_f32 v7, v7, v8
    v_add_f32 v9, v9, v10
    v_add_f32 v7, v7, v9
    s_nop 1
    v_add_f32_dpp v7, v7, v7 quad_perm:[1,0,3,2] row_mask:0xf bank_mask:0xf
    s_nop 1
    v_add_f32_dpp v7, v7, v7 quad_perm:[2,3,0,1] row_mask:0xf bank_mask:0xf
    s_nop 1
    v_add_f32_dpp v7, v7, v7 row_half_mirror row_mask:0xf bank_mask:0xf
    s_nop 1
    v_cvt_pk_bf16_f32 v8, v7, v7
    v_lshlrev_b32 v7, 16, v8
    v_cmp_gt_f32 vcc, v7, v4
    s_cbranch_vccnz L_resc_17
L_cont_18:
    v_fma_f32 v8, v7, s33, -v5
    v_exp_f32 v8, v8
    s_nop 0
    v_add_f32 v6, v6, v8
    v_cvt_pk_bf16_f32 v9, v8, 0
    v_cvt_pk_bf16_f32 v10, 0, v8
    s_waitcnt vmcnt(28)
    v_dot2c_f32_bf16 v32, v176, v9
    v_dot2c_f32_bf16 v33, v176, v10
    v_dot2c_f32_bf16 v34, v177, v9
    v_dot2c_f32_bf16 v35, v177, v10
    v_dot2c_f32_bf16 v36, v178, v9
    v_dot2c_f32_bf16 v37, v178, v10
    v_dot2c_f32_bf16 v38, v179, v9
    v_dot2c_f32_bf16 v39, v179, v10
    v_dot2c_f32_bf16 v40, v180, v9
    v_dot2c_f32_bf16 v41, v180, v10
    v_dot2c_f32_bf16 v42, v181, v9
    v_dot2c_f32_bf16 v43, v181, v10
    v_dot2c_f32_bf16 v44, v182, v9
    v_dot2c_f32_bf16 v45, v182, v10
    v_dot2c_f32_bf16 v46, v183, v9
    v_dot2c_f32_bf16 v47, v183, v10
    v_dot2c_f32_bf16 v48, v184, v9
    v_dot2c_f32_bf16 v49, v184, v10
    v_dot2c_f32_bf16 v50, v185, v9
    v_dot2c_f32_bf16 v51, v185, v10
    v_dot2c_f32_bf16 v52, v186, v9
    v_dot2c_f32_bf16 v53, v186, v10
    v_dot2c_f32_bf16 v54, v187, v9
    v_dot2c_f32_bf16 v55, v187, v10
    v_dot2c_f32_bf16 v56, v188, v9
    v_dot2c_f32_bf16 v57, v188, v10
    v_dot2c_f32_bf16 v58, v189, v9
    v_dot2c_f32_bf16 v59, v189, v10
    v_dot2c_f32_bf16 v60, v190, v9
    v_dot2c_f32_bf16 v61, v190, v10
    v_dot2c_f32_bf16 v62, v191, v9
    v_dot2c_f32_bf16 v63, v191, v10
    buffer_load_dwordx4 v[176:179], v14, s[8:11], 0 offen nt
    buffer_load_dwordx4 v[180:183], v14, s[8:11], 0 offen offset:128 nt
    buffer_load_dwordx4 v[184:187], v14, s[8:11], 0 offen offset:256 nt
    buffer_load_dwordx4 v[188:191], v14, s[8:11], 0 offen offset:384 nt
    s_barrier
    s_waitcnt vmcnt(28)
    v_dot2_f32_bf16 v7, v192, v16, 0
    v_dot2_f32_bf16 v8, v193, v17, 0
    v_dot2_f32_bf16 v9, v194, v18, 0
    v_dot2_f32_bf16 v10, v195, v19, 0
    v_dot2c_f32_bf16 v7, v196, v20
    v_dot2c_f32_bf16 v8, v197, v21
    v_dot2c_f32_bf16 v9, v198, v22
    v_dot2c_f32_bf16 v10, v199, v23
    v_dot2c_f32_bf16 v7, v200, v24
    v_dot2c_f32_bf16 v8, v201, v25
    v_dot2c_f32_bf16 v9, v202, v26
    v_dot2c_f32_bf16 v10, v203, v27
    v_dot2c_f32_bf16 v7, v204, v28
    v_dot2c_f32_bf16 v8, v205, v29
    v_dot2c_f32_bf16 v9, v206, v30
    v_dot2c_f32_bf16 v10, v207, v31
    s_mul_i32 s49, s32, 0
    s_add_u32 s49, s49, s26
    s_and_b32 s49, s49, 15
    s_lshl_b32 s47, s32, 4
    s_add_u32 s49, s49, s47
    s_and_b32 s46, s49, 7
    s_lshl_b32 s46, s46, 6
    s_lshr_b32 s47, s49, 3
    s_add_u32 s46, s46, s47
    s_add_u32 s46, s46, s56
    s_and_b32 s46, s46, 511
    s_lshl_b32 s46, s46, 3
    s_add_u32 s46, s46, s55
    s_lshl_b32 s46, s46, 12
    s_add_u32 s46, s46, s29
    v_add_u32 v15, s46, v2
    s_add_u32 s32, s32, 1
    buffer_load_dwordx4 v[192:195], v15, s[4:7], 0 offen nt
    buffer_load_dwordx4 v[196:199], v15, s[4:7], 0 offen offset:128 nt
    buffer_load_dwordx4 v[200:203], v15, s[4:7], 0 offen offset:256 nt
    buffer_load_dwordx4 v[204:207], v15, s[4:7], 0 offen offset:384 nt
    v_add_f32 v7, v7, v8
    v_add_f32 v9, v9, v10
    v_add_f32 v7, v7, v9
    s_nop 1
    v_add_f32_dpp v7, v7, v7 quad_perm:[1,0,3,2] row_mask:0xf bank_mask:0xf
    s_nop 1
    v_add_f32_dpp v7, v7, v7 quad_perm:[2,3,0,1] row_mask:0xf bank_mask:0xf
    s_nop 1
    v_add_f32_dpp v7, v7, v7 row_half_mirror row_mask:0xf bank_mask:0xf
    s_nop 1
    v_cvt_pk_bf16_f32 v8, v7, v7
    v_lshlrev_b32 v7, 16, v8
    v_cmp_gt_f32 vcc, v7, v4
    s_cbranch_vccnz L_resc_19
L_cont_20:
    v_fma_f32 v8, v7, s33, -v5
    v_exp_f32 v8, v8
    s_nop 0
    v_add_f32 v6, v6, v8
    v_cvt_pk_bf16_f32 v9, v8, 0
    v_cvt_pk_bf16_f32 v10, 0, v8
    s_waitcnt vmcnt(28)
    v_dot2c_f32_bf16 v32, v208, v9
    v_dot2c_f32_bf16 v33, v208, v10
    v_dot2c_f32_bf16 v34, v209, v9
    v_dot2c_f32_bf16 v35, v209, v10
    v_dot2c_f32_bf16 v36, v210, v9
    v_dot2c_f32_bf16 v37, v210, v10
    v_dot2c_f32_bf16 v38, v211, v9
    v_dot2c_f32_bf16 v39, v211, v10
    v_dot2c_f32_bf16 v40, v212, v9
    v_dot2c_f32_bf16 v41, v212, v10
    v_dot2c_f32_bf16 v42, v213, v9
    v_dot2c_f32_bf16 v43, v213, v10
    v_dot2c_f32_bf16 v44, v214, v9
    v_dot2c_f32_bf16 v45, v214, v10
    v_dot2c_f32_bf16 v46, v215, v9
    v_dot2c_f32_bf16 v47, v215, v10
    v_dot2c_f32_bf16 v48, v216, v9
    v_dot2c_f32_bf16 v49, v216, v10
    v_dot2c_f32_bf16 v50, v217, v9
    v_dot2c_f32_bf16 v51, v217, v10
    v_dot2c_f32_bf16 v52, v218, v9
    v_dot2c_f32_bf16 v53, v218, v10
    v_dot2c_f32_bf16 v54, v219, v9
    v_dot2c_f32_bf16 v55, v219, v10
    v_dot2c_f32_bf16 v56, v220, v9
    v_dot2c_f32_bf16 v57, v220, v10
    v_dot2c_f32_bf16 v58, v221, v9
    v_dot2c_f32_bf16 v59, v221, v10
    v_dot2c_f32_bf16 v60, v222, v9
    v_dot2c_f32_bf16 v61, v222, v10
    v_dot2c_f32_bf16 v62, v223, v9
    v_dot2c_f32_bf16 v63, v223, v10
    buffer_load_dwordx4 v[208:211], v15, s[8:11], 0 offen nt
    buffer_load_dwordx4 v[212:215], v15, s[8:11], 0 offen offset:128 nt
    buffer_load_dwordx4 v[216:219], v15, s[8:11], 0 offen offset:256 nt
    buffer_load_dwordx4 v[220:223], v15, s[8:11], 0 offen offset:384 nt
    s_add_u32 s34, s34, 4
    s_cmp_eq_u32 s34, 4
    s_cbranch_scc1 L_wload
    s_cmp_eq_u32 s34, 8
    s_cbranch_scc1 L_xgload
L_loop_back:
    s_cmp_lt_u32 s34, 12
    s_cbranch_scc1 L_loop
    s_add_u32 s37, s26, 336
    v_mov_b32 v224, s37
    v_mov_b32 v225, 0
    ds_write_b32 v225, v224 offset:1216
    s_mov_b32 s53, 1
    s_mov_b32 s54, 1
    s_mov_b32 s58, 0
    s_mov_b64 s[76:77], -1
    s_mov_b64 s[78:79], -1
    v_mov_b32 v3, 0xff61b1e6
    s_cmp_eq_u32 s35, 0
    s_cselect_b32 s74, 0, 16
    s_sub_u32 s74, 512, s74
    s_mov_b32 s75, 0
    s_mov_b32 s71, 0
    s_mov_b32 s70, 0
    s_mov_b32 s41, 0x05040100
    s_mov_b32 s42, 0x07060302
    s_mul_i32 s48, s25, 4352
    s_add_u32 s48, s48, 0x1e8000
    s_barrier
    s_waitcnt vmcnt(28)
    v_dot2_f32_bf16 v7, v96, v16, 0
    v_dot2_f32_bf16 v8, v97, v17, 0
    v_dot2_f32_bf16 v9, v98, v18, 0
    v_dot2_f32_bf16 v10, v99, v19, 0
    v_dot2c_f32_bf16 v7, v100, v20
    v_dot2c_f32_bf16 v8, v101, v21
    v_dot2c_f32_bf16 v9, v102, v22
    v_dot2c_f32_bf16 v10, v103, v23
    v_dot2c_f32_bf16 v7, v104, v24
    v_dot2c_f32_bf16 v8, v105, v25
    v_dot2c_f32_bf16 v9, v106, v26
    v_dot2c_f32_bf16 v10, v107, v27
    v_dot2c_f32_bf16 v7, v108, v28
    v_dot2c_f32_bf16 v8, v109, v29
    v_dot2c_f32_bf16 v9, v110, v30
    v_dot2c_f32_bf16 v10, v111, v31
    s_nop 2
    v_add_f32 v7, v7, v8
    v_add_f32 v9, v9, v10
    v_add_f32 v7, v7, v9
    s_nop 1
    v_add_f32_dpp v7, v7, v7 quad_perm:[1,0,3,2] row_mask:0xf bank_mask:0xf
    s_nop 1
    v_add_f32_dpp v7, v7, v7 quad_perm:[2,3,0,1] row_mask:0xf bank_mask:0xf
    s_nop 1
    v_add_f32_dpp v7, v7, v7 row_half_mirror row_mask:0xf bank_mask:0xf
    s_nop 1
    v_cvt_pk_bf16_f32 v8, v7, v7
    v_lshlrev_b32 v7, 16, v8
    v_cmp_gt_f32 vcc, v7, v4
    s_cbranch_vccnz L_resc_21
L_cont_22:
    v_fma_f32 v8, v7, s33, -v5
    v_exp_f32 v8, v8
    s_nop 0
    v_add_f32 v6, v6, v8
    v_cvt_pk_bf16_f32 v9, v8, 0
    v_cvt_pk_bf16_f32 v10, 0, v8
    s_waitcnt vmcnt(24)
    v_dot2c_f32_bf16 v32, v112, v9
    v_dot2c_f32_bf16 v33, v112, v10
    v_dot2c_f32_bf16 v34, v113, v9
    v_dot2c_f32_bf16 v35, v113, v10
    v_dot2c_f32_bf16 v36, v114, v9
    v_dot2c_f32_bf16 v37, v114, v10
    v_dot2c_f32_bf16 v38, v115, v9
    v_dot2c_f32_bf16 v39, v115, v10
    v_dot2c_f32_bf16 v40, v116, v9
    v_dot2c_f32_bf16 v41, v116, v10
    v_dot2c_f32_bf16 v42, v117, v9
    v_dot2c_f32_bf16 v43, v117, v10
    v_dot2c_f32_bf16 v44, v118, v9
    v_dot2c_f32_bf16 v45, v118, v10
    v_dot2c_f32_bf16 v46, v119, v9
    v_dot2c_f32_bf16 v47, v119, v10
    v_dot2c_f32_bf16 v48, v120, v9
    v_dot2c_f32_bf16 v49, v120, v10
    v_dot2c_f32_bf16 v50, v121, v9
    v_dot2c_f32_bf16 v51, v121, v10
    v_dot2c_f32_bf16 v52, v122, v9
    v_dot2c_f32_bf16 v53, v122, v10
    v_dot2c_f32_bf16 v54, v123, v9
    v_dot2c_f32_bf16 v55, v123, v10
    v_dot2c_f32_bf16 v56, v124, v9
    v_dot2c_f32_bf16 v57, v124, v10
    v_dot2c_f32_bf16 v58, v125, v9
    v_dot2c_f32_bf16 v59, v125, v10
    v_dot2c_f32_bf16 v60, v126, v9
    v_dot2c_f32_bf16 v61, v126, v10
    v_dot2c_f32_bf16 v62, v127, v9
    v_dot2c_f32_bf16 v63, v127, v10
    s_cmp_eq_u32 s35, 0
    s_cbranch_scc1 L_xgs_23
    s_mov_b32 exec_lo, -1
    s_mov_b32 exec_hi, 0
    v_cmp_ne_u32 vcc, s27, v237
    s_cbranch_vccz L_xgok_24
    v_lshlrev_b32 v238, 3, v1
    v_add_u32 v238, 0x9800, v238
L_poll_25:
    buffer_load_dwordx2 v[236:237], v238, s[12:15], 0 offen sc1
    s_waitcnt vmcnt(0)
    v_xor_b32 v232, s27, v237
    v_cmp_ne_u32 vcc, 0, v232
    s_cbranch_vccz L_ok_26
    s_sub_u32 s30, s30, 1
    s_cbranch_scc0 L_poll_25
    s_mov_b32 s30, 0
L_ok_26:
L_xgok_24:
    s_getreg_b32 s37, hwreg(HW_REG_XCC_ID)
    s_and_b32 s37, s37, 15
    v_cmp_ne_u32 vcc, s37, v236
    s_cmp_eq_u64 vcc, 0
    s_cselect_b32 s57, 1, 0
    s_mov_b64 exec, -1
L_xgs_23:
    s_barrier
    s_waitcnt vmcnt(20)
    v_dot2_f32_bf16 v7, v128, v16, 0
    v_dot2_f32_bf16 v8, v129, v17, 0
    v_dot2_f32_bf16 v9, v130, v18, 0
    v_dot2_f32_bf16 v10, v131, v19, 0
    v_dot2c_f32_bf16 v7, v132, v20
    v_dot2c_f32_bf16 v8, v133, v21
    v_dot2c_f32_bf16 v9, v134, v22
    v_dot2c_f32_bf16 v10, v135, v23
    v_dot2c_f32_bf16 v7, v136, v24
    v_dot2c_f32_bf16 v8, v137, v25
    v_dot2c_f32_bf16 v9, v138, v26
    v_dot2c_f32_bf16 v10, v139, v27
    v_dot2c_f32_bf16 v7, v140, v28
    v_dot2c_f32_bf16 v8, v141, v29
    v_dot2c_f32_bf16 v9, v142, v30
    v_dot2c_f32_bf16 v10, v143, v31
    s_nop 2
    v_add_f32 v7, v7, v8
    v_add_f32 v9, v9, v10
    v_add_f32 v7, v7, v9
    s_nop 1
    v_add_f32_dpp v7, v7, v7 quad_perm:[1,0,3,2] row_mask:0xf bank_mask:0xf
    s_nop 1
    v_add_f32_dpp v7, v7, v7 quad_perm:[2,3,0,1] row_mask:0xf bank_mask:0xf
    s_nop 1
    v_add_f32_dpp v7, v7, v7 row_half_mirror row_mask:0xf bank_mask:0xf
    s_nop 1
    v_cvt_pk_bf16_f32 v8, v7, v7
    v_lshlrev_b32 v7, 16, v8
    v_cmp_gt_f32 vcc, v7, v4
    s_cbranch_vccnz L_resc_27
L_cont_28:
    v_fma_f32 v8, v7, s33, -v5
    v_exp_f32 v8, v8
    s_nop 0
    v_add_f32 v6, v6, v8
    v_cvt_pk_bf16_f32 v9, v8, 0
    v_cvt_pk_bf16_f32 v10, 0, v8
    s_waitcnt vmcnt(16)
    v_dot2c_f32_bf16 v32, v144, v9
    v_dot2c_f32_bf16 v33, v144, v10
    v_dot2c_f32_bf16 v34, v145, v9
    v_dot2c_f32_bf16 v35, v145, v10
    v_dot2c_f32_bf16 v36, v146, v9
    v_dot2c_f32_bf16 v37, v146, v10
    v_dot2c_f32_bf16 v38, v147, v9
    v_dot2c_f32_bf16 v39, v147, v10
    v_dot2c_f32_bf16 v40, v148, v9
    v_dot2c_f32_bf16 v41, v148, v10
    v_dot2c_f32_bf16 v42, v149, v9
    v_dot2c_f32_bf16 v43, v149, v10
    v_dot2c_f32_bf16 v44, v150, v9
    v_dot2c_f32_bf16 v45, v150, v10
    v_dot2c_f32_bf16 v46, v151, v9
    v_dot2c_f32_bf16 v47, v151, v10
    v_dot2c_f32_bf16 v48, v152, v9
    v_dot2c_f32_bf16 v49, v152, v10
    v_dot2c_f32_bf16 v50, v153, v9
    v_dot2c_f32_bf16 v51, v153, v10
    v_dot2c_f32_bf16 v52, v154, v9
    v_dot2c_f32_bf16 v53, v154, v10
    v_dot2c_f32_bf16 v54, v155, v9
    v_dot2c_f32_bf16 v55, v155, v10
    v_dot2c_f32_bf16 v56, v156, v9
    v_dot2c_f32_bf16 v57, v156, v10
    v_dot2c_f32_bf16 v58, v157, v9
    v_dot2c_f32_bf16 v59, v157, v10
    v_dot2c_f32_bf16 v60, v158, v9
    v_dot2c_f32_bf16 v61, v158, v10
    v_dot2c_f32_bf16 v62, v159, v9
    v_dot2c_f32_bf16 v63, v159, v10
    s_waitcnt lgkmcnt(0)
    s_cmp_eq_u32 s35, 0
    s_cbranch_scc1 L_wol_29
    s_mov_b32 s16, s72
    s_mov_b32 s17, s73
    s_mov_b32 s18, 0x380000
    s_mov_b32 s19, 0x20000
    s_lshl_b32 s37, s25, 4
    s_and_b32 s38, s26, 8
    s_add_u32 s37, s37, s38
    s_add_u32 s37, s37, s24
    s_mul_i32 s37, s37, 14336
    v_lshlrev_b32 v232, 4, v1
    buffer_load_dwordx4 v[96:99], v232, s[16:19], s37 offen nt
    s_add_u32 s37, s37, 896
    buffer_load_dwordx4 v[100:103], v232, s[16:19], s37 offen nt
    s_add_u32 s37, s37, 896
    buffer_load_dwordx4 v[104:107], v232, s[16:19], s37 offen nt
    s_add_u32 s37, s37, 896
    buffer_load_dwordx4 v[108:111], v232, s[16:19], s37 offen nt
    s_add_u32 s37, s37, 896
    buffer_load_dwordx4 v[112:115], v232, s[16:19], s37 offen nt
    s_add_u32 s37, s37, 896
    buffer_load_dwordx4 v[116:119], v232, s[16:19], s37 offen nt
    s_add_u32 s37, s37, 896
    buffer_load_dwordx4 v[120:123], v232, s[16:19], s37 offen nt
    s_add_u32 s37, s37, 896
    buffer_load_dwordx4 v[124:127], v232, s[16:19], s37 offen nt
    s_add_u32 s37, s37, 896
    buffer_load_dwordx4 v[128:131], v232, s[16:19], s37 offen nt
    s_add_u32 s37, s37, 896
    buffer_load_dwordx4 v[132:135], v232, s[16:19], s37 offen nt
    s_add_u32 s37, s37, 896
    buffer_load_dwordx4 v[136:139], v232, s[16:19], s37 offen nt
    s_add_u32 s37, s37, 896
    buffer_load_dwordx4 v[140:143], v232, s[16:19], s37 offen nt
    s_add_u32 s37, s37, 896
    buffer_load_dwordx4 v[144:147], v232, s[16:19], s37 offen nt
    s_add_u32 s37, s37, 896
    buffer_load_dwordx4 v[148:151], v232, s[16:19], s37 offen nt
    s_add_u32 s37, s37, 896
    buffer_load_dwordx4 v[152:155], v232, s[16:19], s37 offen nt
    s_add_u32 s37, s37, 896
    buffer_load_dwordx4 v[156:159], v232, s[16:19], s37 offen nt
    s_add_u32 s37, s37, 896
L_wol_29:
    s_barrier
    s_waitcnt vmcnt(12)
    v_dot2_f32_bf16 v7, v160, v16, 0
    v_dot2_f32_bf16 v8, v161, v17, 0
    v_dot2_f32_bf16 v9, v162, v18, 0
    v_dot2_f32_bf16 v10, v163, v19, 0
    v_dot2c_f32_bf16 v7, v164, v20
    v_dot2c_f32_bf16 v8, v165, v21
    v_dot2c_f32_bf16 v9, v166, v22
    v_dot2c_f32_bf16 v10, v167, v23
    v_dot2c_f32_bf16 v7, v168, v24
    v_dot2c_f32_bf16 v8, v169, v25
    v_dot2c_f32_bf16 v9, v170, v26
    v_dot2c_f32_bf16 v10, v171, v27
    v_dot2c_f32_bf16 v7, v172, v28
    v_dot2c_f32_bf16 v8, v173, v29
    v_dot2c_f32_bf16 v9, v174, v30
    v_dot2c_f32_bf16 v10, v175, v31
    s_nop 2
    v_add_f32 v7, v7, v8
    v_add_f32 v9, v9, v10
    v_add_f32 v7, v7, v9
    s_nop 1
    v_add_f32_dpp v7, v7, v7 quad_perm:[1,0,3,2] row_mask:0xf bank_mask:0xf
    s_nop 1
    v_add_f32_dpp v7, v7, v7 quad_perm:[2,3,0,1] row_mask:0xf bank_mask:0xf
    s_nop 1
    v_add_f32_dpp v7, v7, v7 row_half_mirror row_mask:0xf bank_mask:0xf
    s_nop 1
    v_cvt_pk_bf16_f32 v8, v7, v7
    v_lshlrev_b32 v7, 16, v8
    v_cmp_gt_f32 vcc, v7, v4
    s_cbranch_vccnz L_resc_30
L_cont_31:
    v_fma_f32 v8, v7, s33, -v5
    v_exp_f32 v8, v8
    s_nop 0
    v_add_f32 v6, v6, v8
    v_cvt_pk_bf16_f32 v9, v8, 0
    v_cvt_pk_bf16_f32 v10, 0, v8
    s_waitcnt vmcnt(8)
    v_dot2c_f32_bf16 v32, v176, v9
    v_dot2c_f32_bf16 v33, v176, v10
    v_dot2c_f32_bf16 v34, v177, v9
    v_dot2c_f32_bf16 v35, v177, v10
    v_dot2c_f32_bf16 v36, v178, v9
    v_dot2c_f32_bf16 v37, v178, v10
    v_dot2c_f32_bf16 v38, v179, v9
    v_dot2c_f32_bf16 v39, v179, v10
    v_dot2c_f32_bf16 v40, v180, v9
    v_dot2c_f32_bf16 v41, v180, v10
    v_dot2c_f32_bf16 v42, v181, v9
    v_dot2c_f32_bf16 v43, v181, v10
    v_dot2c_f32_bf16 v44, v182, v9
    v_dot2c_f32_bf16 v45, v182, v10
    v_dot2c_f32_bf16 v46, v183, v9
    v_dot2c_f32_bf16 v47, v183, v10
    v_dot2c_f32_bf16 v48, v184, v9
    v_dot2c_f32_bf16 v49, v184, v10
    v_dot2c_f32_bf16 v50, v185, v9
    v_dot2c_f32_bf16 v51, v185, v10
    v_dot2c_f32_bf16 v52, v186, v9
    v_dot2c_f32_bf16 v53, v186, v10
    v_dot2c_f32_bf16 v54, v187, v9
    v_dot2c_f32_bf16 v55, v187, v10
    v_dot2c_f32_bf16 v56, v188, v9
    v_dot2c_f32_bf16 v57, v188, v10
    v_dot2c_f32_bf16 v58, v189, v9
    v_dot2c_f32_bf16 v59, v189, v10
    v_dot2c_f32_bf16 v60, v190, v9
    v_dot2c_f32_bf16 v61, v190, v10
    v_dot2c_f32_bf16 v62, v191, v9
    v_dot2c_f32_bf16 v63, v191, v10
L_dyn:
    s_barrier
    ds_read_b32 v226, v225 offset:1216
    s_cmp_eq_u32 s53, 0
    s_cbranch_scc1 L_s0
    s_waitcnt lgkmcnt(0)
    v_readfirstlane_b32 s52, v226
    s_cmp_lg_u32 s24, 0
    s_cbranch_scc1 L_noclaim_32
    s_mov_b32 s70, 0
    s_cmp_ge_u32 s52, s74
    s_cbranch_scc1 L_noclaim_32
    s_mov_b32 s70, 1
    v_mov_b32 v227, 1
    s_mov_b64 exec, 1
    buffer_atomic_add v227, v225, s[12:15], s48 offen sc0 nt
    s_mov_b64 exec, -1
L_noclaim_32:
    s_waitcnt vmcnt(4)
    v_dot2_f32_bf16 v7, v192, v16, 0
    v_dot2_f32_bf16 v8, v193, v17, 0
    v_dot2_f32_bf16 v9, v194, v18, 0
    v_dot2_f32_bf16 v10, v195, v19, 0
    v_dot2c_f32_bf16 v7, v196, v20
    v_dot2c_f32_bf16 v8, v197, v21
    v_dot2c_f32_bf16 v9, v198, v22
    v_dot2c_f32_bf16 v10, v199, v23
    v_dot2c_f32_bf16 v7, v200, v24
    v_dot2c_f32_bf16 v8, v201, v25
    v_dot2c_f32_bf16 v9, v202, v26
    v_dot2c_f32_bf16 v10, v203, v27
    v_dot2c_f32_bf16 v7, v204, v28
    v_dot2c_f32_bf16 v8, v205, v29
    v_dot2c_f32_bf16 v9, v206, v30
    v_dot2c_f32_bf16 v10, v207, v31
    s_and_b32 s46, s52, 7
    s_lshl_b32 s46, s46, 6
    s_lshr_b32 s47, s52, 3
    s_add_u32 s46, s46, s47
    s_add_u32 s46, s46, s56
    s_and_b32 s46, s46, 511
    s_lshl_b32 s46, s46, 3
    s_add_u32 s46, s46, s55
    s_lshl_b32 s46, s46, 12
    s_add_u32 s46, s46, s29
    s_cmp_lt_u32 s52, 512
    s_cselect_b32 s46, s46, 0x80000000
    s_cselect_b32 s62, -1, 1
    s_cselect_b32 s63, -1, 0
    v_add_u32 v15, s46, v2
    s_mov_b64 exec, s[62:63]
    buffer_load_dwordx4 v[192:195], v15, s[4:7], 0 offen nt
    buffer_load_dwordx4 v[196:199], v15, s[4:7], 0 offen offset:128 nt
    buffer_load_dwordx4 v[200:203], v15, s[4:7], 0 offen offset:256 nt
    buffer_load_dwordx4 v[204:207], v15, s[4:7], 0 offen offset:384 nt
    s_mov_b64 exec, -1
    v_add_f32 v7, v7, v8
    v_add_f32 v9, v9, v10
    v_add_f32 v7, v7, v9
    s_nop 1
    v_add_f32_dpp v7, v7, v7 quad_perm:[1,0,3,2] row_mask:0xf bank_mask:0xf
    s_nop 1
    v_add_f32_dpp v7, v7, v7 quad_perm:[2,3,0,1] row_mask:0xf bank_mask:0xf
    s_nop 1
    v_add_f32_dpp v7, v7, v7 row_half_mirror row_mask:0xf bank_mask:0xf
    s_nop 1
    v_cvt_pk_bf16_f32 v8, v7, v7
    v_lshlrev_b32 v7, 16, v8
    v_cmp_gt_f32 vcc, v7, v4
    s_cbranch_vccnz L_resc_33
L_cont_34:
    v_fma_f32 v8, v7, s33, -v5
    v_exp_f32 v8, v8
    s_nop 0
    v_add_f32 v6, v6, v8
    v_cvt_pk_bf16_f32 v9, v8, 0
    v_cvt_pk_bf16_f32 v10, 0, v8
    s_waitcnt vmcnt(4)
    v_dot2c_f32_bf16 v32, v208, v9
    v_dot2c_f32_bf16 v33, v208, v10
    v_dot2c_f32_bf16 v34, v209, v9
    v_dot2c_f32_bf16 v35, v209, v10
    v_dot2c_f32_bf16 v36, v210, v9
    v_dot2c_f32_bf16 v37, v210, v10
    v_dot2c_f32_bf16 v38, v211, v9
    v_dot2c_f32_bf16 v39, v211, v10
    v_dot2c_f32_bf16 v40, v212, v9
    v_dot2c_f32_bf16 v41, v212, v10
    v_dot2c_f32_bf16 v42, v213, v9
    v_dot2c_f32_bf16 v43, v213, v10
    v_dot2c_f32_bf16 v44, v214, v9
    v_dot2c_f32_bf16 v45, v214, v10
    v_dot2c_f32_bf16 v46, v215, v9
    v_dot2c_f32_bf16 v47, v215, v10
    v_dot2c_f32_bf16 v48, v216, v9
    v_dot2c_f32_bf16 v49, v216, v10
    v_dot2c_f32_bf16 v50, v217, v9
    v_dot2c_f32_bf16 v51, v217, v10
    v_dot2c_f32_bf16 v52, v218, v9
    v_dot2c_f32_bf16 v53, v218, v10
    v_dot2c_f32_bf16 v54, v219, v9
    v_dot2c_f32_bf16 v55, v219, v10
    v_dot2c_f32_bf16 v56, v220, v9
    v_dot2c_f32_bf16 v57, v220, v10
    v_dot2c_f32_bf16 v58, v221, v9
    v_dot2c_f32_bf16 v59, v221, v10
    v_dot2c_f32_bf16 v60, v222, v9
    v_dot2c_f32_bf16 v61, v222, v10
    v_dot2c_f32_bf16 v62, v223, v9
    v_dot2c_f32_bf16 v63, v223, v10
    s_mov_b64 exec, s[62:63]
    buffer_load_dwordx4 v[208:211], v15, s[8:11], 0 offen nt
    buffer_load_dwordx4 v[212:215], v15, s[8:11], 0 offen offset:128 nt
    buffer_load_dwordx4 v[216:219], v15, s[8:11], 0 offen offset:256 nt
    buffer_load_dwordx4 v[220:223], v15, s[8:11], 0 offen offset:384 nt
    s_mov_b64 exec, -1
    s_cmp_lt_u32 s52, 512
    s_cselect_b32 s53, 1, 0
    s_add_u32 s75, s75, 1
    s_cmp_lg_u32 s75, 2
    s_cbranch_scc1 L_wop_35
    s_cmp_eq_u32 s35, 0
    s_cbranch_scc1 L_wop_35
L_wop_35:
    s_cmp_lg_u32 s24, 0
    s_cbranch_scc1 L_nopub_36
    s_waitcnt vmcnt(8)
    v_add_u32 v227, 352, v227
    v_mov_b32 v228, 0xffff
    s_cmp_eq_u32 s70, 1
    s_cselect_b64 vcc, -1, 0
    v_cndmask_b32 v228, v228, v227, vcc
    s_mov_b64 exec, 1
    ds_write_b32 v225, v228 offset:1220
    s_mov_b64 exec, -1
    s_waitcnt lgkmcnt(0)
L_nopub_36:
    s_barrier
    ds_read_b32 v226, v225 offset:1220
    s_cmp_eq_u32 s53, 0
    s_cbranch_scc1 L_s0
    s_waitcnt lgkmcnt(0)
    v_readfirstlane_b32 s52, v226
    s_cmp_lg_u32 s24, 0
    s_cbranch_scc1 L_noclaim_37
    s_mov_b32 s70, 0
    s_cmp_ge_u32 s52, s74
    s_cbranch_scc1 L_noclaim_37
    s_mov_b32 s70, 1
    v_mov_b32 v227, 1
    s_mov_b64 exec, 1
    buffer_atomic_add v227, v225, s[12:15], s48 offen sc0 nt
    s_mov_b64 exec, -1
L_noclaim_37:
    s_waitcnt vmcnt(4)
    v_dot2_f32_bf16 v7, v192, v16, 0
    v_dot2_f32_bf16 v8, v193, v17, 0
    v_dot2_f32_bf16 v9, v194, v18, 0
    v_dot2_f32_bf16 v10, v195, v19, 0
    v_dot2c_f32_bf16 v7, v196, v20
    v_dot2c_f32_bf16 v8, v197, v21
    v_dot2c_f32_bf16 v9, v198, v22
    v_dot2c_f32_bf16 v10, v199, v23
    v_dot2c_f32_bf16 v7, v200, v24
    v_dot2c_f32_bf16 v8, v201, v25
    v_dot2c_f32_bf16 v9, v202, v26
    v_dot2c_f32_bf16 v10, v203, v27
    v_dot2c_f32_bf16 v7, v204, v28
    v_dot2c_f32_bf16 v8, v205, v29
    v_dot2c_f32_bf16 v9, v206, v30
    v_dot2c_f32_bf16 v10, v207, v31
    s_and_b32 s46, s52, 7
    s_lshl_b32 s46, s46, 6
    s_lshr_b32 s47, s52, 3
    s_add_u32 s46, s46, s47
    s_add_u32 s46, s46, s56
    s_and_b32 s46, s46, 511
    s_lshl_b32 s46, s46, 3
    s_add_u32 s46, s46, s55
    s_lshl_b32 s46, s46, 12
    s_add_u32 s46, s46, s29
    s_cmp_lt_u32 s52, 512
    s_cselect_b32 s46, s46, 0x80000000
    s_cselect_b32 s62, -1, 1
    s_cselect_b32 s63, -1, 0
    v_add_u32 v15, s46, v2
    s_mov_b64 exec, s[62:63]
    buffer_load_dwordx4 v[192:195], v15, s[4:7], 0 offen nt
    buffer_load_dwordx4 v[196:199], v15, s[4:7], 0 offen offset:128 nt
    buffer_load_dwordx4 v[200:203], v15, s[4:7], 0 offen offset:256 nt
    buffer_load_dwordx4 v[204:207], v15, s[4:7], 0 offen offset:384 nt
    s_mov_b64 exec, -1
    v_add_f32 v7, v7, v8
    v_add_f32 v9, v9, v10
    v_add_f32 v7, v7, v9
    s_nop 1
    v_add_f32_dpp v7, v7, v7 quad_perm:[1,0,3,2] row_mask:0xf bank_mask:0xf
    s_nop 1
    v_add_f32_dpp v7, v7, v7 quad_perm:[2,3,0,1] row_mask:0xf bank_mask:0xf
    s_nop 1
    v_add_f32_dpp v7, v7, v7 row_half_mirror row_mask:0xf bank_mask:0xf
    s_nop 1
    v_cvt_pk_bf16_f32 v8, v7, v7
    v_lshlrev_b32 v7, 16, v8
    v_cmp_gt_f32 vcc, v7, v4
    s_cbranch_vccnz L_resc_38
L_cont_39:
    v_fma_f32 v8, v7, s33, -v5
    v_exp_f32 v8, v8
    s_nop 0
    v_add_f32 v6, v6, v8
    v_cvt_pk_bf16_f32 v9, v8, 0
    v_cvt_pk_bf16_f32 v10, 0, v8
    s_waitcnt vmcnt(4)
    v_dot2c_f32_bf16 v32, v208, v9
    v_dot2c_f32_bf16 v33, v208, v10
    v_dot2c_f32_bf16 v34, v209, v9
    v_dot2c_f32_bf16 v35, v209, v10
    v_dot2c_f32_bf16 v36, v210, v9
    v_dot2c_f32_bf16 v37, v210, v10
    v_dot2c_f32_bf16 v38, v211, v9
    v_dot2c_f32_bf16 v39, v211, v10
    v_dot2c_f32_bf16 v40, v212, v9
    v_dot2c_f32_bf16 v41, v212, v10
    v_dot2c_f32_bf16 v42, v213, v9
    v_dot2c_f32_bf16 v43, v213, v10
    v_dot2c_f32_bf16 v44, v214, v9
    v_dot2c_f32_bf16 v45, v214, v10
    v_dot2c_f32_bf16 v46, v215, v9
    v_dot2c_f32_bf16 v47, v215, v10
    v_dot2c_f32_bf16 v48, v216, v9
    v_dot2c_f32_bf16 v49, v216, v10
    v_dot2c_f32_bf16 v50, v217, v9
    v_dot2c_f32_bf16 v51, v217, v10
    v_dot2c_f32_bf16 v52, v218, v9
    v_dot2c_f32_bf16 v53, v218, v10
    v_dot2c_f32_bf16 v54, v219, v9
    v_dot2c_f32_bf16 v55, v219, v10
    v_dot2c_f32_bf16 v56, v220, v9
    v_dot2c_f32_bf16 v57, v220, v10
    v_dot2c_f32_bf16 v58, v221, v9
    v_dot2c_f32_bf16 v59, v221, v10
    v_dot2c_f32_bf16 v60, v222, v9
    v_dot2c_f32_bf16 v61, v222, v10
    v_dot2c_f32_bf16 v62, v223, v9
    v_dot2c_f32_bf16 v63, v223, v10
    s_mov_b64 exec, s[62:63]
    buffer_load_dwordx4 v[208:211], v15, s[8:11], 0 offen nt
    buffer_load_dwordx4 v[212:215], v15, s[8:11], 0 offen offset:128 nt
    buffer_load_dwordx4 v[216:219], v15, s[8:11], 0 offen offset:256 nt
    buffer_load_dwordx4 v[220:223], v15, s[8:11], 0 offen offset:384 nt
    s_mov_b64 exec, -1
    s_cmp_lt_u32 s52, 512
    s_cselect_b32 s53, 1, 0
    s_add_u32 s75, s75, 1
    s_cmp_lg_u32 s75, 2
    s_cbranch_scc1 L_wop_40
    s_cmp_eq_u32 s35, 0
    s_cbranch_scc1 L_wop_40
    v_perm_b32 v9, v100, v96, s41
    v_perm_b32 v100, v100, v96, s42
    v_mov_b32 v96, v9
    v_perm_b32 v9, v101, v97, s41
    v_perm_b32 v101, v101, v97, s42
    v_mov_b32 v97, v9
    v_perm_b32 v9, v102, v98, s41
    v_perm_b32 v102, v102, v98, s42
    v_mov_b32 v98, v9
    v_perm_b32 v9, v103, v99, s41
    v_perm_b32 v103, v103, v99, s42
    v_mov_b32 v99, v9
    v_perm_b32 v9, v108, v104, s41
    v_perm_b32 v108, v108, v104, s42
    v_mov_b32 v104, v9
    v_perm_b32 v9, v109, v105, s41
    v_perm_b32 v109, v109, v105, s42
    v_mov_b32 v105, v9
    v_perm_b32 v9, v110, v106, s41
    v_perm_b32 v110, v110, v106, s42
    v_mov_b32 v106, v9
    v_perm_b32 v9, v111, v107, s41
    v_perm_b32 v111, v111, v107, s42
    v_mov_b32 v107, v9
    v_perm_b32 v9, v116, v112, s41
    v_perm_b32 v116, v116, v112, s42
    v_mov_b32 v112, v9
    v_perm_b32 v9, v117, v113, s41
    v_perm_b32 v117, v117, v113, s42
    v_mov_b32 v113, v9
    v_perm_b32 v9, v118, v114, s41
    v_perm_b32 v118, v118, v114, s42
    v_mov_b32 v114, v9
    v_perm_b32 v9, v119, v115, s41
    v_perm_b32 v119, v119, v115, s42
    v_mov_b32 v115, v9
    v_perm_b32 v9, v124, v120, s41
    v_perm_b32 v124, v124, v120, s42
    v_mov_b32 v120, v9
    v_perm_b32 v9, v125, v121, s41
    v_perm_b32 v125, v125, v121, s42
    v_mov_b32 v121, v9
    v_perm_b32 v9, v126, v122, s41
    v_perm_b32 v126, v126, v122, s42
    v_mov_b32 v122, v9
    v_perm_b32 v9, v127, v123, s41
    v_perm_b32 v127, v127, v123, s42
    v_mov_b32 v123, v9
    v_perm_b32 v9, v132, v128, s41
    v_perm_b32 v132, v132, v128, s42
    v_mov_b32 v128, v9
    v_perm_b32 v9, v133, v129, s41
    v_perm_b32 v133, v133, v129, s42
    v_mov_b32 v129, v9
    v_perm_b32 v9, v134, v130, s41
    v_perm_b32 v134, v134, v130, s42
    v_mov_b32 v130, v9
    v_perm_b32 v9, v135, v131, s41
    v_perm_b32 v135, v135, v131, s42
    v_mov_b32 v131, v9
    v_perm_b32 v9, v140, v136, s41
    v_perm_b32 v140, v140, v136, s42
    v_mov_b32 v136, v9
    v_perm_b32 v9, v141, v137, s41
    v_perm_b32 v141, v141, v137, s42
    v_mov_b32 v137, v9
    v_perm_b32 v9, v142, v138, s41
    v_perm_b32 v142, v142, v138, s42
    v_mov_b32 v138, v9
    v_perm_b32 v9, v143, v139, s41
    v_perm_b32 v143, v143, v139, s42
    v_mov_b32 v139, v9
    v_perm_b32 v9, v148, v144, s41
    v_perm_b32 v148, v148, v144, s42
    v_mov_b32 v144, v9
    v_perm_b32 v9, v149, v145, s41
    v_perm_b32 v149, v149, v145, s42
    v_mov_b32 v145, v9
    v_perm_b32 v9, v150, v146, s41
    v_perm_b32 v150, v150, v146, s42
    v_mov_b32 v146, v9
    v_perm_b32 v9, v151, v147, s41
    v_perm_b32 v151, v151, v147, s42
    v_mov_b32 v147, v9
    v_perm_b32 v9, v156, v152, s41
    v_perm_b32 v156, v156, v152, s42
    v_mov_b32 v152, v9
    v_perm_b32 v9, v157, v153, s41
    v_perm_b32 v157, v157, v153, s42
    v_mov_b32 v153, v9
    v_perm_b32 v9, v158, v154, s41
    v_perm_b32 v158, v158, v154, s42
    v_mov_b32 v154, v9
    v_perm_b32 v9, v159, v155, s41
    v_perm_b32 v159, v159, v155, s42
    v_mov_b32 v155, v9
L_wop_40:
    s_cmp_lg_u32 s24, 0
    s_cbranch_scc1 L_nopub_41
    s_waitcnt vmcnt(8)
    v_add_u32 v227, 352, v227
    v_mov_b32 v228, 0xffff
    s_cmp_eq_u32 s70, 1
    s_cselect_b64 vcc, -1, 0
    v_cndmask_b32 v228, v228, v227, vcc
    s_mov_b64 exec, 1
    ds_write_b32 v225, v228 offset:1216
    s_mov_b64 exec, -1
    s_waitcnt lgkmcnt(0)
L_nopub_41:
    s_branch L_dyn
L_resc_3:
    v_mov_b32 v8, v7
    s_nop 1
    v_max_f32_dpp v8, v8, v8 row_ror:8 row_mask:0xf bank_mask:0xf
    s_nop 1
    v_max_f32_dpp v8, v8, v8 row_bcast:15 row_mask:0xa bank_mask:0xf
    s_nop 1
    v_max_f32_dpp v8, v8, v8 row_bcast:31 row_mask:0xc bank_mask:0xf
    s_nop 0
    v_readlane_b32 s47, v8, 63
    s_nop 1
    v_max_f32 v9, s47, v4
    v_sub_f32 v10, v4, v9
    v_mul_f32 v10, s33, v10
    v_exp_f32 v10, v10
    v_mov_b32 v4, v9
    v_mul_f32 v5, s33, v9
    v_mul_f32 v6, v10, v6
    v_mul_f32 v32, v10, v32
    v_mul_f32 v33, v10, v33
    v_mul_f32 v34, v10, v34
    v_mul_f32 v35, v10, v35
    v_mul_f32 v36, v10, v36
    v_mul_f32 v37, v10, v37
    v_mul_f32 v38, v10, v38
    v_mul_f32 v39, v10, v39
    v_mul_f32 v40, v10, v40
    v_mul_f32 v41, v10, v41
    v_mul_f32 v42, v10, v42
    v_mul_f32 v43, v10, v43
    v_mul_f32 v44, v10, v44
    v_mul_f32 v45, v10, v45
    v_mul_f32 v46, v10, v46
    v_mul_f32 v47, v10, v47
    v_mul_f32 v48, v10, v48
    v_mul_f32 v49, v10, v49
    v_mul_f32 v50, v10, v50
    v_mul_f32 v51, v10, v51
    v_mul_f32 v52, v10, v52
    v_mul_f32 v53, v10, v53
    v_mul_f32 v54, v10, v54
    v_mul_f32 v55, v10, v55
    v_mul_f32 v56, v10, v56
    v_mul_f32 v57, v10, v57
    v_mul_f32 v58, v10, v58
    v_mul_f32 v59, v10, v59
    v_mul_f32 v60, v10, v60
    v_mul_f32 v61, v10, v61
    v_mul_f32 v62, v10, v62
    v_mul_f32 v63, v10, v63
    s_branch L_cont_4
L_resc_5:
    v_mov_b32 v8, v7
    s_nop 1
    v_max_f32_dpp v8, v8, v8 row_ror:8 row_mask:0xf bank_mask:0xf
    s_nop 1
    v_max_f32_dpp v8, v8, v8 row_bcast:15 row_mask:0xa bank_mask:0xf
    s_nop 1
    v_max_f32_dpp v8, v8, v8 row_bcast:31 row_mask:0xc bank_mask:0xf
    s_nop 0
    v_readlane_b32 s47, v8, 63
    s_nop 1
    v_max_f32 v9, s47, v4
    v_sub_f32 v10, v4, v9
    v_mul_f32 v10, s33, v10
    v_exp_f32 v10, v10
    v_mov_b32 v4, v9
    v_mul_f32 v5, s33, v9
    v_mul_f32 v6, v10, v6
    v_mul_f32 v32, v10, v32
    v_mul_f32 v33, v10, v33
    v_mul_f32 v34, v10, v34
    v_mul_f32 v35, v10, v35
    v_mul_f32 v36, v10, v36
    v_mul_f32 v37, v10, v37
    v_mul_f32 v38, v10, v38
    v_mul_f32 v39, v10, v39
    v_mul_f32 v40, v10, v40
    v_mul_f32 v41, v10, v41
    v_mul_f32 v42, v10, v42
    v_mul_f32 v43, v10, v43
    v_mul_f32 v44, v10, v44
    v_mul_f32 v45, v10, v45
    v_mul_f32 v46, v10, v46
    v_mul_f32 v47, v10, v47
    v_mul_f32 v48, v10, v48
    v_mul_f32 v49, v10, v49
    v_mul_f32 v50, v10, v50
    v_mul_f32 v51, v10, v51
    v_mul_f32 v52, v10, v52
    v_mul_f32 v53, v10, v53
    v_mul_f32 v54, v10, v54
    v_mul_f32 v55, v10, v55
    v_mul_f32 v56, v10, v56
    v_mul_f32 v57, v10, v57
    v_mul_f32 v58, v10, v58
    v_mul_f32 v59, v10, v59
    v_mul_f32 v60, v10, v60
    v_mul_f32 v61, v10, v61
    v_mul_f32 v62, v10, v62
    v_mul_f32 v63, v10, v63
    s_branch L_cont_6
L_resc_7:
    v_mov_b32 v8, v7
    s_nop 1
    v_max_f32_dpp v8, v8, v8 row_ror:8 row_mask:0xf bank_mask:0xf
    s_nop 1
    v_max_f32_dpp v8, v8, v8 row_bcast:15 row_mask:0xa bank_mask:0xf
    s_nop 1
    v_max_f32_dpp v8, v8, v8 row_bcast:31 row_mask:0xc bank_mask:0xf
    s_nop 0
    v_readlane_b32 s47, v8, 63
    s_nop 1
    v_max_f32 v9, s47, v4
    v_sub_f32 v10, v4, v9
    v_mul_f32 v10, s33, v10
    v_exp_f32 v10, v10
    v_mov_b32 v4, v9
    v_mul_f32 v5, s33, v9
    v_mul_f32 v6, v10, v6
    v_mul_f32 v32, v10, v32
    v_mul_f32 v33, v10, v33
    v_mul_f32 v34, v10, v34
    v_mul_f32 v35, v10, v35
    v_mul_f32 v36, v10, v36
    v_mul_f32 v37, v10, v37
    v_mul_f32 v38, v10, v38
    v_mul_f32 v39, v10, v39
    v_mul_f32 v40, v10, v40
    v_mul_f32 v41, v10, v41
    v_mul_f32 v42, v10, v42
    v_mul_f32 v43, v10, v43
    v_mul_f32 v44, v10, v44
    v_mul_f32 v45, v10, v45
    v_mul_f32 v46, v10, v46
    v_mul_f32 v47, v10, v47
    v_mul_f32 v48, v10, v48
    v_mul_f32 v49, v10, v49
    v_mul_f32 v50, v10, v50
    v_mul_f32 v51, v10, v51
    v_mul_f32 v52, v10, v52
    v_mul_f32 v53, v10, v53
    v_mul_f32 v54, v10, v54
    v_mul_f32 v55, v10, v55
    v_mul_f32 v56, v10, v56
    v_mul_f32 v57, v10, v57
    v_mul_f32 v58, v10, v58
    v_mul_f32 v59, v10, v59
    v_mul_f32 v60, v10, v60
    v_mul_f32 v61, v10, v61
    v_mul_f32 v62, v10, v62
    v_mul_f32 v63, v10, v63
    s_branch L_cont_8
L_resc_9:
    v_mov_b32 v8, v7
    s_nop 1
    v_max_f32_dpp v8, v8, v8 row_ror:8 row_mask:0xf bank_mask:0xf
    s_nop 1
    v_max_f32_dpp v8, v8, v8 row_bcast:15 row_mask:0xa bank_mask:0xf
    s_nop 1
    v_max_f32_dpp v8, v8, v8 row_bcast:31 row_mask:0xc bank_mask:0xf
    s_nop 0
    v_readlane_b32 s47, v8, 63
    s_nop 1
    v_max_f32 v9, s47, v4
    v_sub_f32 v10, v4, v9
    v_mul_f32 v10, s33, v10
    v_exp_f32 v10, v10
    v_mov_b32 v4, v9
    v_mul_f32 v5, s33, v9
    v_mul_f32 v6, v10, v6
    v_mul_f32 v32, v10, v32
    v_mul_f32 v33, v10, v33
    v_mul_f32 v34, v10, v34
    v_mul_f32 v35, v10, v35
    v_mul_f32 v36, v10, v36
    v_mul_f32 v37, v10, v37
    v_mul_f32 v38, v10, v38
    v_mul_f32 v39, v10, v39
    v_mul_f32 v40, v10, v40
    v_mul_f32 v41, v10, v41
    v_mul_f32 v42, v10, v42
    v_mul_f32 v43, v10, v43
    v_mul_f32 v44, v10, v44
    v_mul_f32 v45, v10, v45
    v_mul_f32 v46, v10, v46
    v_mul_f32 v47, v10, v47
    v_mul_f32 v48, v10, v48
    v_mul_f32 v49, v10, v49
    v_mul_f32 v50, v10, v50
    v_mul_f32 v51, v10, v51
    v_mul_f32 v52, v10, v52
    v_mul_f32 v53, v10, v53
    v_mul_f32 v54, v10, v54
    v_mul_f32 v55, v10, v55
    v_mul_f32 v56, v10, v56
    v_mul_f32 v57, v10, v57
    v_mul_f32 v58, v10, v58
    v_mul_f32 v59, v10, v59
    v_mul_f32 v60, v10, v60
    v_mul_f32 v61, v10, v61
    v_mul_f32 v62, v10, v62
    v_mul_f32 v63, v10, v63
    s_branch L_cont_10
L_resc_11:
    v_mov_b32 v8, v7
    s_nop 1
    v_max_f32_dpp v8, v8, v8 row_ror:8 row_mask:0xf bank_mask:0xf
    s_nop 1
    v_max_f32_dpp v8, v8, v8 row_bcast:15 row_mask:0xa bank_mask:0xf
    s_nop 1
    v_max_f32_dpp v8, v8, v8 row_bcast:31 row_mask:0xc bank_mask:0xf
    s_nop 0
    v_readlane_b32 s47, v8, 63
    s_nop 1
    v_max_f32 v9, s47, v4
    v_sub_f32 v10, v4, v9
    v_mul_f32 v10, s33, v10
    v_exp_f32 v10, v10
    v_mov_b32 v4, v9
    v_mul_f32 v5, s33, v9
    v_mul_f32 v6, v10, v6
    v_mul_f32 v32, v10, v32
    v_mul_f32 v33, v10, v33
    v_mul_f32 v34, v10, v34
    v_mul_f32 v35, v10, v35
    v_mul_f32 v36, v10, v36
    v_mul_f32 v37, v10, v37
    v_mul_f32 v38, v10, v38
    v_mul_f32 v39, v10, v39
    v_mul_f32 v40, v10, v40
    v_mul_f32 v41, v10, v41
    v_mul_f32 v42, v10, v42
    v_mul_f32 v43, v10, v43
    v_mul_f32 v44, v10, v44
    v_mul_f32 v45, v10, v45
    v_mul_f32 v46, v10, v46
    v_mul_f32 v47, v10, v47
    v_mul_f32 v48, v10, v48
    v_mul_f32 v49, v10, v49
    v_mul_f32 v50, v10, v50
    v_mul_f32 v51, v10, v51
    v_mul_f32 v52, v10, v52
    v_mul_f32 v53, v10, v53
    v_mul_f32 v54, v10, v54
    v_mul_f32 v55, v10, v55
    v_mul_f32 v56, v10, v56
    v_mul_f32 v57, v10, v57
    v_mul_f32 v58, v10, v58
    v_mul_f32 v59, v10, v59
    v_mul_f32 v60, v10, v60
    v_mul_f32 v61, v10, v61
    v_mul_f32 v62, v10, v62
    v_mul_f32 v63, v10, v63
    s_branch L_cont_12
L_resc_13:
    v_mov_b32 v8, v7
    s_nop 1
    v_max_f32_dpp v8, v8, v8 row_ror:8 row_mask:0xf bank_mask:0xf
    s_nop 1
    v_max_f32_dpp v8, v8, v8 row_bcast:15 row_mask:0xa bank_mask:0xf
    s_nop 1
    v_max_f32_dpp v8, v8, v8 row_bcast:31 row_mask:0xc bank_mask:0xf
    s_nop 0
    v_readlane_b32 s47, v8, 63
    s_nop 1
    v_max_f32 v9, s47, v4
    v_sub_f32 v10, v4, v9
    v_mul_f32 v10, s33, v10
    v_exp_f32 v10, v10
    v_mov_b32 v4, v9
    v_mul_f32 v5, s33, v9
    v_mul_f32 v6, v10, v6
    v_mul_f32 v32, v10, v32
    v_mul_f32 v33, v10, v33
    v_mul_f32 v34, v10, v34
    v_mul_f32 v35, v10, v35
    v_mul_f32 v36, v10, v36
    v_mul_f32 v37, v10, v37
    v_mul_f32 v38, v10, v38
    v_mul_f32 v39, v10, v39
    v_mul_f32 v40, v10, v40
    v_mul_f32 v41, v10, v41
    v_mul_f32 v42, v10, v42
    v_mul_f32 v43, v10, v43
    v_mul_f32 v44, v10, v44
    v_mul_f32 v45, v10, v45
    v_mul_f32 v46, v10, v46
    v_mul_f32 v47, v10, v47
    v_mul_f32 v48, v10, v48
    v_mul_f32 v49, v10, v49
    v_mul_f32 v50, v10, v50
    v_mul_f32 v51, v10, v51
    v_mul_f32 v52, v10, v52
    v_mul_f32 v53, v10, v53
    v_mul_f32 v54, v10, v54
    v_mul_f32 v55, v10, v55
    v_mul_f32 v56, v10, v56
    v_mul_f32 v57, v10, v57
    v_mul_f32 v58, v10, v58
    v_mul_f32 v59, v10, v59
    v_mul_f32 v60, v10, v60
    v_mul_f32 v61, v10, v61
    v_mul_f32 v62, v10, v62
    v_mul_f32 v63, v10, v63
    s_branch L_cont_14
L_resc_15:
    v_mov_b32 v8, v7
    s_nop 1
    v_max_f32_dpp v8, v8, v8 row_ror:8 row_mask:0xf bank_mask:0xf
    s_nop 1
    v_max_f32_dpp v8, v8, v8 row_bcast:15 row_mask:0xa bank_mask:0xf
    s_nop 1
    v_max_f32_dpp v8, v8, v8 row_bcast:31 row_mask:0xc bank_mask:0xf
    s_nop 0
    v_readlane_b32 s47, v8, 63
    s_nop 1
    v_max_f32 v9, s47, v4
    v_sub_f32 v10, v4, v9
    v_mul_f32 v10, s33, v10
    v_exp_f32 v10, v10
    v_mov_b32 v4, v9
    v_mul_f32 v5, s33, v9
    v_mul_f32 v6, v10, v6
    v_mul_f32 v32, v10, v32
    v_mul_f32 v33, v10, v33
    v_mul_f32 v34, v10, v34
    v_mul_f32 v35, v10, v35
    v_mul_f32 v36, v10, v36
    v_mul_f32 v37, v10, v37
    v_mul_f32 v38, v10, v38
    v_mul_f32 v39, v10, v39
    v_mul_f32 v40, v10, v40
    v_mul_f32 v41, v10, v41
    v_mul_f32 v42, v10, v42
    v_mul_f32 v43, v10, v43
    v_mul_f32 v44, v10, v44
    v_mul_f32 v45, v10, v45
    v_mul_f32 v46, v10, v46
    v_mul_f32 v47, v10, v47
    v_mul_f32 v48, v10, v48
    v_mul_f32 v49, v10, v49
    v_mul_f32 v50, v10, v50
    v_mul_f32 v51, v10, v51
    v_mul_f32 v52, v10, v52
    v_mul_f32 v53, v10, v53
    v_mul_f32 v54, v10, v54
    v_mul_f32 v55, v10, v55
    v_mul_f32 v56, v10, v56
    v_mul_f32 v57, v10, v57
    v_mul_f32 v58, v10, v58
    v_mul_f32 v59, v10, v59
    v_mul_f32 v60, v10, v60
    v_mul_f32 v61, v10, v61
    v_mul_f32 v62, v10, v62
    v_mul_f32 v63, v10, v63
    s_branch L_cont_16
L_resc_17:
    v_mov_b32 v8, v7
    s_nop 1
    v_max_f32_dpp v8, v8, v8 row_ror:8 row_mask:0xf bank_mask:0xf
    s_nop 1
    v_max_f32_dpp v8, v8, v8 row_bcast:15 row_mask:0xa bank_mask:0xf
    s_nop 1
    v_max_f32_dpp v8, v8, v8 row_bcast:31 row_mask:0xc bank_mask:0xf
    s_nop 0
    v_readlane_b32 s47, v8, 63
    s_nop 1
    v_max_f32 v9, s47, v4
    v_sub_f32 v10, v4, v9
    v_mul_f32 v10, s33, v10
    v_exp_f32 v10, v10
    v_mov_b32 v4, v9
    v_mul_f32 v5, s33, v9
    v_mul_f32 v6, v10, v6
    v_mul_f32 v32, v10, v32
    v_mul_f32 v33, v10, v33
    v_mul_f32 v34, v10, v34
    v_mul_f32 v35, v10, v35
    v_mul_f32 v36, v10, v36
    v_mul_f32 v37, v10, v37
    v_mul_f32 v38, v10, v38
    v_mul_f32 v39, v10, v39
    v_mul_f32 v40, v10, v40
    v_mul_f32 v41, v10, v41
    v_mul_f32 v42, v10, v42
    v_mul_f32 v43, v10, v43
    v_mul_f32 v44, v10, v44
    v_mul_f32 v45, v10, v45
    v_mul_f32 v46, v10, v46
    v_mul_f32 v47, v10, v47
    v_mul_f32 v48, v10, v48
    v_mul_f32 v49, v10, v49
    v_mul_f32 v50, v10, v50
    v_mul_f32 v51, v10, v51
    v_mul_f32 v52, v10, v52
    v_mul_f32 v53, v10, v53
    v_mul_f32 v54, v10, v54
    v_mul_f32 v55, v10, v55
    v_mul_f32 v56, v10, v56
    v_mul_f32 v57, v10, v57
    v_mul_f32 v58, v10, v58
    v_mul_f32 v59, v10, v59
    v_mul_f32 v60, v10, v60
    v_mul_f32 v61, v10, v61
    v_mul_f32 v62, v10, v62
    v_mul_f32 v63, v10, v63
    s_branch L_cont_18
L_resc_19:
    v_mov_b32 v8, v7
    s_nop 1
    v_max_f32_dpp v8, v8, v8 row_ror:8 row_mask:0xf bank_mask:0xf
    s_nop 1
    v_max_f32_dpp v8, v8, v8 row_bcast:15 row_mask:0xa bank_mask:0xf
    s_nop 1
    v_max_f32_dpp v8, v8, v8 row_bcast:31 row_mask:0xc bank_mask:0xf
    s_nop 0
    v_readlane_b32 s47, v8, 63
    s_nop 1
    v_max_f32 v9, s47, v4
    v_sub_f32 v10, v4, v9
    v_mul_f32 v10, s33, v10
    v_exp_f32 v10, v10
    v_mov_b32 v4, v9
    v_mul_f32 v5, s33, v9
    v_mul_f32 v6, v10, v6
    v_mul_f32 v32, v10, v32
    v_mul_f32 v33, v10, v33
    v_mul_f32 v34, v10, v34
    v_mul_f32 v35, v10, v35
    v_mul_f32 v36, v10, v36
    v_mul_f32 v37, v10, v37
    v_mul_f32 v38, v10, v38
    v_mul_f32 v39, v10, v39
    v_mul_f32 v40, v10, v40
    v_mul_f32 v41, v10, v41
    v_mul_f32 v42, v10, v42
    v_mul_f32 v43, v10, v43
    v_mul_f32 v44, v10, v44
    v_mul_f32 v45, v10, v45
    v_mul_f32 v46, v10, v46
    v_mul_f32 v47, v10, v47
    v_mul_f32 v48, v10, v48
    v_mul_f32 v49, v10, v49
    v_mul_f32 v50, v10, v50
    v_mul_f32 v51, v10, v51
    v_mul_f32 v52, v10, v52
    v_mul_f32 v53, v10, v53
    v_mul_f32 v54, v10, v54
    v_mul_f32 v55, v10, v55
    v_mul_f32 v56, v10, v56
    v_mul_f32 v57, v10, v57
    v_mul_f32 v58, v10, v58
    v_mul_f32 v59, v10, v59
    v_mul_f32 v60, v10, v60
    v_mul_f32 v61, v10, v61
    v_mul_f32 v62, v10, v62
    v_mul_f32 v63, v10, v63
    s_branch L_cont_20
L_resc_21:
    v_mov_b32 v8, v7
    s_nop 1
    v_max_f32_dpp v8, v8, v8 row_ror:8 row_mask:0xf bank_mask:0xf
    s_nop 1
    v_max_f32_dpp v8, v8, v8 row_bcast:15 row_mask:0xa bank_mask:0xf
    s_nop 1
    v_max_f32_dpp v8, v8, v8 row_bcast:31 row_mask:0xc bank_mask:0xf
    s_nop 0
    v_readlane_b32 s47, v8, 63
    s_nop 1
    v_max_f32 v9, s47, v4
    v_sub_f32 v10, v4, v9
    v_mul_f32 v10, s33, v10
    v_exp_f32 v10, v10
    v_mov_b32 v4, v9
    v_mul_f32 v5, s33, v9
    v_mul_f32 v6, v10, v6
    v_mul_f32 v32, v10, v32
    v_mul_f32 v33, v10, v33
    v_mul_f32 v34, v10, v34
    v_mul_f32 v35, v10, v35
    v_mul_f32 v36, v10, v36
    v_mul_f32 v37, v10, v37
    v_mul_f32 v38, v10, v38
    v_mul_f32 v39, v10, v39
    v_mul_f32 v40, v10, v40
    v_mul_f32 v41, v10, v41
    v_mul_f32 v42, v10, v42
    v_mul_f32 v43, v10, v43
    v_mul_f32 v44, v10, v44
    v_mul_f32 v45, v10, v45
    v_mul_f32 v46, v10, v46
    v_mul_f32 v47, v10, v47
    v_mul_f32 v48, v10, v48
    v_mul_f32 v49, v10, v49
    v_mul_f32 v50, v10, v50
    v_mul_f32 v51, v10, v51
    v_mul_f32 v52, v10, v52
    v_mul_f32 v53, v10, v53
    v_mul_f32 v54, v10, v54
    v_mul_f32 v55, v10, v55
    v_mul_f32 v56, v10, v56
    v_mul_f32 v57, v10, v57
    v_mul_f32 v58, v10, v58
    v_mul_f32 v59, v10, v59
    v_mul_f32 v60, v10, v60
    v_mul_f32 v61, v10, v61
    v_mul_f32 v62, v10, v62
    v_mul_f32 v63, v10, v63
    s_branch L_cont_22
L_resc_27:
    v_mov_b32 v8, v7
    s_nop 1
    v_max_f32_dpp v8, v8, v8 row_ror:8 row_mask:0xf bank_mask:0xf
    s_nop 1
    v_max_f32_dpp v8, v8, v8 row_bcast:15 row_mask:0xa bank_mask:0xf
    s_nop 1
    v_max_f32_dpp v8, v8, v8 row_bcast:31 row_mask:0xc bank_mask:0xf
    s_nop 0
    v_readlane_b32 s47, v8, 63
    s_nop 1
    v_max_f32 v9, s47, v4
    v_sub_f32 v10, v4, v9
    v_mul_f32 v10, s33, v10
    v_exp_f32 v10, v10
    v_mov_b32 v4, v9
    v_mul_f32 v5, s33, v9
    v_mul_f32 v6, v10, v6
    v_mul_f32 v32, v10, v32
    v_mul_f32 v33, v10, v33
    v_mul_f32 v34, v10, v34
    v_mul_f32 v35, v10, v35
    v_mul_f32 v36, v10, v36
    v_mul_f32 v37, v10, v37
    v_mul_f32 v38, v10, v38
    v_mul_f32 v39, v10, v39
    v_mul_f32 v40, v10, v40
    v_mul_f32 v41, v10, v41
    v_mul_f32 v42, v10, v42
    v_mul_f32 v43, v10, v43
    v_mul_f32 v44, v10, v44
    v_mul_f32 v45, v10, v45
    v_mul_f32 v46, v10, v46
    v_mul_f32 v47, v10, v47
    v_mul_f32 v48, v10, v48
    v_mul_f32 v49, v10, v49
    v_mul_f32 v50, v10, v50
    v_mul_f32 v51, v10, v51
    v_mul_f32 v52, v10, v52
    v_mul_f32 v53, v10, v53
    v_mul_f32 v54, v10, v54
    v_mul_f32 v55, v10, v55
    v_mul_f32 v56, v10, v56
    v_mul_f32 v57, v10, v57
    v_mul_f32 v58, v10, v58
    v_mul_f32 v59, v10, v59
    v_mul_f32 v60, v10, v60
    v_mul_f32 v61, v10, v61
    v_mul_f32 v62, v10, v62
    v_mul_f32 v63, v10, v63
    s_branch L_cont_28
L_resc_30:
    v_mov_b32 v8, v7
    s_nop 1
    v_max_f32_dpp v8, v8, v8 row_ror:8 row_mask:0xf bank_mask:0xf
    s_nop 1
    v_max_f32_dpp v8, v8, v8 row_bcast:15 row_mask:0xa bank_mask:0xf
    s_nop 1
    v_max_f32_dpp v8, v8, v8 row_bcast:31 row_mask:0xc bank_mask:0xf
    s_nop 0
    v_readlane_b32 s47, v8, 63
    s_nop 1
    v_max_f32 v9, s47, v4
    v_sub_f32 v10, v4, v9
    v_mul_f32 v10, s33, v10
    v_exp_f32 v10, v10
    v_mov_b32 v4, v9
    v_mul_f32 v5, s33, v9
    v_mul_f32 v6, v10, v6
    v_mul_f32 v32, v10, v32
    v_mul_f32 v33, v10, v33
    v_mul_f32 v34, v10, v34
    v_mul_f32 v35, v10, v35
    v_mul_f32 v36, v10, v36
    v_mul_f32 v37, v10, v37
    v_mul_f32 v38, v10, v38
    v_mul_f32 v39, v10, v39
    v_mul_f32 v40, v10, v40
    v_mul_f32 v41, v10, v41
    v_mul_f32 v42, v10, v42
    v_mul_f32 v43, v10, v43
    v_mul_f32 v44, v10, v44
    v_mul_f32 v45, v10, v45
    v_mul_f32 v46, v10, v46
    v_mul_f32 v47, v10, v47
    v_mul_f32 v48, v10, v48
    v_mul_f32 v49, v10, v49
    v_mul_f32 v50, v10, v50
    v_mul_f32 v51, v10, v51
    v_mul_f32 v52, v10, v52
    v_mul_f32 v53, v10, v53
    v_mul_f32 v54, v10, v54
    v_mul_f32 v55, v10, v55
    v_mul_f32 v56, v10, v56
    v_mul_f32 v57, v10, v57
    v_mul_f32 v58, v10, v58
    v_mul_f32 v59, v10, v59
    v_mul_f32 v60, v10, v60
    v_mul_f32 v61, v10, v61
    v_mul_f32 v62, v10, v62
    v_mul_f32 v63, v10, v63
    s_branch L_cont_31
L_resc_33:
    v_mov_b32 v8, v7
    s_nop 1
    v_max_f32_dpp v8, v8, v8 row_ror:8 row_mask:0xf bank_mask:0xf
    s_nop 1
    v_max_f32_dpp v8, v8, v8 row_bcast:15 row_mask:0xa bank_mask:0xf
    s_nop 1
    v_max_f32_dpp v8, v8, v8 row_bcast:31 row_mask:0xc bank_mask:0xf
    s_nop 0
    v_readlane_b32 s47, v8, 63
    s_nop 1
    v_max_f32 v9, s47, v4
    v_sub_f32 v10, v4, v9
    v_mul_f32 v10, s33, v10
    v_exp_f32 v10, v10
    v_mov_b32 v4, v9
    v_mul_f32 v5, s33, v9
    v_mul_f32 v6, v10, v6
    v_mul_f32 v32, v10, v32
    v_mul_f32 v33, v10, v33
    v_mul_f32 v34, v10, v34
    v_mul_f32 v35, v10, v35
    v_mul_f32 v36, v10, v36
    v_mul_f32 v37, v10, v37
    v_mul_f32 v38, v10, v38
    v_mul_f32 v39, v10, v39
    v_mul_f32 v40, v10, v40
    v_mul_f32 v41, v10, v41
    v_mul_f32 v42, v10, v42
    v_mul_f32 v43, v10, v43
    v_mul_f32 v44, v10, v44
    v_mul_f32 v45, v10, v45
    v_mul_f32 v46, v10, v46
    v_mul_f32 v47, v10, v47
    v_mul_f32 v48, v10, v48
    v_mul_f32 v49, v10, v49
    v_mul_f32 v50, v10, v50
    v_mul_f32 v51, v10, v51
    v_mul_f32 v52, v10, v52
    v_mul_f32 v53, v10, v53
    v_mul_f32 v54, v10, v54
    v_mul_f32 v55, v10, v55
    v_mul_f32 v56, v10, v56
    v_mul_f32 v57, v10, v57
    v_mul_f32 v58, v10, v58
    v_mul_f32 v59, v10, v59
    v_mul_f32 v60, v10, v60
    v_mul_f32 v61, v10, v61
    v_mul_f32 v62, v10, v62
    v_mul_f32 v63, v10, v63
    s_branch L_cont_34
L_resc_38:
    v_mov_b32 v8, v7
    s_nop 1
    v_max_f32_dpp v8, v8, v8 row_ror:8 row_mask:0xf bank_mask:0xf
    s_nop 1
    v_max_f32_dpp v8, v8, v8 row_bcast:15 row_mask:0xa bank_mask:0xf
    s_nop 1
    v_max_f32_dpp v8, v8, v8 row_bcast:31 row_mask:0xc bank_mask:0xf
    s_nop 0
    v_readlane_b32 s47, v8, 63
    s_nop 1
    v_max_f32 v9, s47, v4
    v_sub_f32 v10, v4, v9
    v_mul_f32 v10, s33, v10
    v_exp_f32 v10, v10
    v_mov_b32 v4, v9
    v_mul_f32 v5, s33, v9
    v_mul_f32 v6, v10, v6
    v_mul_f32 v32, v10, v32
    v_mul_f32 v33, v10, v33
    v_mul_f32 v34, v10, v34
    v_mul_f32 v35, v10, v35
    v_mul_f32 v36, v10, v36
    v_mul_f32 v37, v10, v37
    v_mul_f32 v38, v10, v38
    v_mul_f32 v39, v10, v39
    v_mul_f32 v40, v10, v40
    v_mul_f32 v41, v10, v41
    v_mul_f32 v42, v10, v42
    v_mul_f32 v43, v10, v43
    v_mul_f32 v44, v10, v44
    v_mul_f32 v45, v10, v45
    v_mul_f32 v46, v10, v46
    v_mul_f32 v47, v10, v47
    v_mul_f32 v48, v10, v48
    v_mul_f32 v49, v10, v49
    v_mul_f32 v50, v10, v50
    v_mul_f32 v51, v10, v51
    v_mul_f32 v52, v10, v52
    v_mul_f32 v53, v10, v53
    v_mul_f32 v54, v10, v54
    v_mul_f32 v55, v10, v55
    v_mul_f32 v56, v10, v56
    v_mul_f32 v57, v10, v57
    v_mul_f32 v58, v10, v58
    v_mul_f32 v59, v10, v59
    v_mul_f32 v60, v10, v60
    v_mul_f32 v61, v10, v61
    v_mul_f32 v62, v10, v62
    v_mul_f32 v63, v10, v63
    s_branch L_cont_39
L_wload:
    s_cmp_eq_u32 s35, 0
    s_cbranch_scc1 L_loop_back
    s_cmp_eq_u32 s35, 1
    s_cbranch_scc1 L_xgpub
    s_mov_b32 s16, s76
    s_mov_b32 s17, s77
    s_mov_b32 s18, 0x188000
    s_mov_b32 s19, 0x20000
    s_mov_b32 s20, s80
    s_mov_b32 s21, s81
    s_mov_b32 s22, 0x188000
    s_mov_b32 s23, 0x20000
    v_lshrrev_b32 v224, 3, v1
    s_movk_i32 s37, 3584
    v_mul_lo_u32 v224, v224, s37
    v_and_b32 v225, 7, v1
    v_lshlrev_b32 v225, 4, v225
    v_add_u32 v224, v224, v225
    s_mul_i32 s37, s24, 200704
    s_lshl_b32 s38, s36, 7
    s_add_u32 s37, s37, s38
    s_mul_i32 s38, s24, 7168
    s_add_u32 s38, s38, 32768
    s_mov_b32 m0, s38
    s_nop 0
    buffer_load_dwordx4 v224, s[16:19], s37 offen nt lds
    s_add_u32 s37, s37, 28672
    s_add_u32 s38, s38, 1024
    s_mov_b32 m0, s38
    s_nop 0
    buffer_load_dwordx4 v224, s[16:19], s37 offen nt lds
    s_add_u32 s37, s37, 28672
    s_add_u32 s38, s38, 1024
    s_mov_b32 m0, s38
    s_nop 0
    buffer_load_dwordx4 v224, s[16:19], s37 offen nt lds
    s_add_u32 s37, s37, 28672
    s_add_u32 s38, s38, 1024
    s_mov_b32 m0, s38
    s_nop 0
    buffer_load_dwordx4 v224, s[16:19], s37 offen nt lds
    s_add_u32 s37, s37, 28672
    s_add_u32 s38, s38, 1024
    s_mov_b32 m0, s38
    s_nop 0
    buffer_load_dwordx4 v224, s[16:19], s37 offen nt lds
    s_add_u32 s37, s37, 28672
    s_add_u32 s38, s38, 1024
    s_mov_b32 m0, s38
    s_nop 0
    buffer_load_dwordx4 v224, s[16:19], s37 offen nt lds
    s_add_u32 s37, s37, 28672
    s_add_u32 s38, s38, 1024
    s_mov_b32 m0, s38
    s_nop 0
    buffer_load_dwordx4 v224, s[16:19], s37 offen nt lds
    s_add_u32 s37, s37, 28672
    s_add_u32 s38, s38, 1024
    v_lshlrev_b32 v226, 4, v1
    s_lshl_b32 s37, s36, 6
    s_lshl_b32 s38, s24, 3
    s_add_u32 s37, s37, s38
    s_mul_i32 s37, s37, 896
    s_lshl_b32 s38, s24, 13
    s_add_u32 s38, s38, 90112
    s_mov_b32 m0, s38
    s_nop 0
    buffer_load_dwordx4 v226, s[20:23], s37 offen nt lds
    s_add_u32 s37, s37, 896
    s_add_u32 s38, s38, 1024
    s_mov_b32 m0, s38
    s_nop 0
    buffer_load_dwordx4 v226, s[20:23], s37 offen nt lds
    s_add_u32 s37, s37, 896
    s_add_u32 s38, s38, 1024
    s_mov_b32 m0, s38
    s_nop 0
    buffer_load_dwordx4 v226, s[20:23], s37 offen nt lds
    s_add_u32 s37, s37, 896
    s_add_u32 s38, s38, 1024
    s_mov_b32 m0, s38
    s_nop 0
    buffer_load_dwordx4 v226, s[20:23], s37 offen nt lds
    s_add_u32 s37, s37, 896
    s_add_u32 s38, s38, 1024
    s_mov_b32 m0, s38
    s_nop 0
    buffer_load_dwordx4 v226, s[20:23], s37 offen nt lds
    s_add_u32 s37, s37, 896
    s_add_u32 s38, s38, 1024
    s_mov_b32 m0, s38
    s_nop 0
    buffer_load_dwordx4 v226, s[20:23], s37 offen nt lds
    s_add_u32 s37, s37, 896
    s_add_u32 s38, s38, 1024
    s_mov_b32 m0, s38
    s_nop 0
    buffer_load_dwordx4 v226, s[20:23], s37 offen nt lds
    s_add_u32 s37, s37, 896
    s_add_u32 s38, s38, 1024
    s_mov_b32 m0, s38
    s_nop 0
    buffer_load_dwordx4 v226, s[20:23], s37 offen nt lds
    s_add_u32 s37, s37, 896
    s_add_u32 s38, s38, 1024
    s_mov_b32 s16, s78
    s_mov_b32 s17, s79
    s_mov_b32 s18, 0xe00
    s_mov_b32 s19, 0x20000
    v_and_b32 v225, 7, v1
    v_lshlrev_b32 v225, 3, v225
    v_lshrrev_b32 v227, 3, v1
    v_add_u32 v225, v225, v227
    v_lshlrev_b32 v225, 1, v225
    s_lshl_b32 s37, s36, 7
    v_add_u32 v225, s37, v225
    buffer_load_ushort v66, v225, s[16:19], 0 offen nt
    s_mov_b32 s16, s64
    s_mov_b32 s17, s65
    s_mov_b32 s18, 0x380
    s_mov_b32 s19, 0x20000
    s_mov_b32 s20, s82
    s_mov_b32 s21, s83
    s_mov_b32 s22, 0x380
    s_mov_b32 s23, 0x20000
    s_lshl_b32 s37, s36, 5
    v_and_b32 v227, 7, v1
    v_lshlrev_b32 v227, 1, v227
    v_lshrrev_b32 v228, 5, v1
    v_add_u32 v227, v227, v228
    v_lshlrev_b32 v227, 1, v227
    v_add_u32 v227, s37, v227
    buffer_load_ushort v65, v227, s[20:23], 0 offen nt
    buffer_load_ushort v64, v227, s[16:19], 0 offen nt
L_xgpub:
    s_cmp_lg_u32 s24, 0
    s_cbranch_scc1 L_loop_back
    s_getreg_b32 s37, hwreg(HW_REG_XCC_ID)
    s_and_b32 s37, s37, 15
    v_mov_b32 v230, s37
    v_mov_b32 v231, s27
    s_lshl_b32 s37, s36, 3
    s_add_u32 s37, s37, 0x9800
    v_mov_b32 v229, 0
    s_mov_b64 exec, 1
    buffer_store_dwordx2 v[230:231], v229, s[12:15], s37 offen sc1
    s_mov_b64 exec, -1
    s_branch L_loop_back
L_xgload:
    s_cmp_eq_u32 s35, 0
    s_cbranch_scc1 L_loop_back
    v_lshlrev_b32 v238, 3, v1
    v_add_u32 v238, 0x9800, v238
    buffer_load_dwordx2 v[236:237], v238, s[12:15], 0 offen sc1
    s_branch L_loop_back
L_s0:
    v_add_f32_dpp v6, v6, v6 row_ror:8 row_mask:0xf bank_mask:0xf
    v_mov_b32 v224, v6
    s_nop 1
    v_permlane16_swap_b32 v6, v224
    s_nop 0
    v_add_f32 v6, v6, v224
    v_mov_b32 v224, v6
    s_nop 1
    v_permlane32_swap_b32 v6, v224
    s_nop 0
    v_add_f32 v6, v6, v224
    s_nop 1
    s_nop 2
    v_permlane32_swap_b32 v32, v48
    v_permlane32_swap_b32 v33, v49
    v_permlane32_swap_b32 v34, v50
    v_permlane32_swap_b32 v35, v51
    v_permlane32_swap_b32 v36, v52
    v_permlane32_swap_b32 v37, v53
    v_permlane32_swap_b32 v38, v54
    v_permlane32_swap_b32 v39, v55
    v_permlane32_swap_b32 v40, v56
    v_permlane32_swap_b32 v41, v57
    v_permlane32_swap_b32 v42, v58
    v_permlane32_swap_b32 v43, v59
    v_permlane32_swap_b32 v44, v60
    v_permlane32_swap_b32 v45, v61
    v_permlane32_swap_b32 v46, v62
    v_permlane32_swap_b32 v47, v63
    s_nop 0
    v_pk_add_f32 v[32:33], v[32:33], v[48:49]
    v_pk_add_f32 v[34:35], v[34:35], v[50:51]
    v_pk_add_f32 v[36:37], v[36:37], v[52:53]
    v_pk_add_f32 v[38:39], v[38:39], v[54:55]
    v_pk_add_f32 v[40:41], v[40:41], v[56:57]
    v_pk_add_f32 v[42:43], v[42:43], v[58:59]
    v_pk_add_f32 v[44:45], v[44:45], v[60:61]
    v_pk_add_f32 v[46:47], v[46:47], v[62:63]
    s_nop 1
    v_permlane16_swap_b32 v32, v40
    v_permlane16_swap_b32 v33, v41
    v_permlane16_swap_b32 v34, v42
    v_permlane16_swap_b32 v35, v43
    v_permlane16_swap_b32 v36, v44
    v_permlane16_swap_b32 v37, v45
    v_permlane16_swap_b32 v38, v46
    v_permlane16_swap_b32 v39, v47
    s_nop 0
    v_pk_add_f32 v[32:33], v[32:33], v[40:41]
    v_pk_add_f32 v[34:35], v[34:35], v[42:43]
    v_pk_add_f32 v[36:37], v[36:37], v[44:45]
    v_pk_add_f32 v[38:39], v[38:39], v[46:47]
    s_nop 1
    v_add_f32_dpp v32, v32, v32 row_ror:8 row_mask:0xf bank_mask:0x3
    v_add_f32_dpp v33, v33, v33 row_ror:8 row_mask:0xf bank_mask:0x3
    v_add_f32_dpp v34, v34, v34 row_ror:8 row_mask:0xf bank_mask:0x3
    v_add_f32_dpp v35, v35, v35 row_ror:8 row_mask:0xf bank_mask:0x3
    v_add_f32_dpp v32, v36, v36 row_ror:8 row_mask:0xf bank_mask:0xc
    v_add_f32_dpp v33, v37, v37 row_ror:8 row_mask:0xf bank_mask:0xc
    v_add_f32_dpp v34, v38, v38 row_ror:8 row_mask:0xf bank_mask:0xc
    v_add_f32_dpp v35, v39, v39 row_ror:8 row_mask:0xf bank_mask:0xc
    s_nop 1
    v_lshrrev_b32 v7, 4, v1
    v_lshlrev_b32 v7, 8, v7
    v_and_b32 v8, 7, v1
    v_lshlrev_b32 v8, 5, v8
    v_bfe_u32 v9, v1, 3, 1
    v_lshlrev_b32 v9, 4, v9
    v_add3_u32 v7, v7, v8, v9
    s_lshl_b32 s37, s24, 10
    v_add_u32 v7, s37, v7
    ds_write_b128 v7, v[32:35] offset:2048
    v_mov_b32 v8, v4
    v_mov_b32 v9, v6
    s_lshl_b32 s37, s24, 3
    v_mov_b32 v10, s37
    ds_write_b64 v10, v[8:9] offset:1024
    s_mov_b32 s41, 0x05040100
    s_mov_b32 s42, 0x07060302
    s_waitcnt vmcnt(0) lgkmcnt(0)
    s_barrier
    s_cmp_gt_u32 s24, 1
    s_cbranch_scc1 L_rw
    v_mov_b32 v7, 0
    ds_read_b128 v[224:227], v7 offset:1024
    ds_read_b128 v[228:231], v7 offset:1040
    ds_read_b128 v[232:235], v7 offset:1056
    ds_read_b128 v[236:239], v7 offset:1072
    v_lshlrev_b32 v8, 3, v0
    ds_read_b64 v[68:69], v8 offset:2048
    ds_read_b64 v[70:71], v8 offset:3072
    ds_read_b64 v[72:73], v8 offset:4096
    ds_read_b64 v[74:75], v8 offset:5120
    ds_read_b64 v[76:77], v8 offset:6144
    ds_read_b64 v[78:79], v8 offset:7168
    ds_read_b64 v[80:81], v8 offset:8192
    ds_read_b64 v[82:83], v8 offset:9216
    s_waitcnt lgkmcnt(8)
    v_max3_f32 v9, v224, v226, v228
    v_max3_f32 v10, v230, v232, v234
    v_max3_f32 v9, v9, v236, v238
    v_max_f32 v9, v9, v10
    v_mul_f32 v11, s33, v9
    v_fma_f32 v224, v224, s33, -v11
    v_fma_f32 v226, v226, s33, -v11
    v_fma_f32 v228, v228, s33, -v11
    v_fma_f32 v230, v230, s33, -v11
    v_fma_f32 v232, v232, s33, -v11
    v_fma_f32 v234, v234, s33, -v11
    v_fma_f32 v236, v236, s33, -v11
    v_fma_f32 v238, v238, s33, -v11
    v_exp_f32 v224, v224
    v_exp_f32 v226, v226
    v_exp_f32 v228, v228
    v_exp_f32 v230, v230
    v_exp_f32 v232, v232
    v_exp_f32 v234, v234
    v_exp_f32 v236, v236
    v_exp_f32 v238, v238
    v_lshrrev_b32 v7, 3, v0
    v_lshlrev_b32 v7, 11, v7
    v_and_b32 v8, 7, v0
    v_cmp_eq_u32 vcc, 0, v8
    v_lshlrev_b32 v8, 4, v8
    v_add_u32 v7, v7, v8
    s_lshl_b32 s37, s25, 15
    s_lshl_b32 s38, s26, 7
    s_add_u32 s37, s37, s38
    s_add_u32 s37, s37, 0x10000
    v_mov_b32 v87, s27
    s_waitcnt lgkmcnt(0)
    v_mul_f32 v84, v224, v68
    v_mul_f32 v85, v224, v69
    v_mul_f32 v10, v224, v225
    v_fmac_f32 v84, v226, v70
    v_fmac_f32 v85, v226, v71
    v_fmac_f32 v10, v226, v227
    v_fmac_f32 v84, v228, v72
    v_fmac_f32 v85, v228, v73
    v_fmac_f32 v10, v228, v229
    v_fmac_f32 v84, v230, v74
    v_fmac_f32 v85, v230, v75
    v_fmac_f32 v10, v230, v231
    v_fmac_f32 v84, v232, v76
    v_fmac_f32 v85, v232, v77
    v_fmac_f32 v10, v232, v233
    v_fmac_f32 v84, v234, v78
    v_fmac_f32 v85, v234, v79
    v_fmac_f32 v10, v234, v235
    v_fmac_f32 v84, v236, v80
    v_fmac_f32 v85, v236, v81
    v_fmac_f32 v10, v236, v237
    v_fmac_f32 v84, v238, v82
    v_fmac_f32 v85, v238, v83
    v_fmac_f32 v10, v238, v239
    v_cndmask_b32 v86, v10, v9, vcc
    buffer_store_dwordx4 v[84:87], v7, s[12:15], s37 offen sc1
L_rw:
    s_cmp_eq_u32 s35, 0
    s_cbranch_scc1 L_end
    v_lshlrev_b32 v50, 4, v1
    s_and_b32 s39, s26, 8
    s_add_u32 s39, s39, s24
    s_lshl_b32 s39, s39, 11
    s_lshl_b32 s38, s25, 15
    s_add_u32 s38, s38, s39
    s_add_u32 s38, s38, 0x10000
    v_add_u32 v50, s38, v50
    buffer_load_dwordx4 v[232:235], v50, s[12:15], 0 offen sc1
    buffer_load_dwordx4 v[236:239], v50, s[12:15], 0 offen offset:1024 sc1
    s_cmp_lt_u32 s35, 2
    s_cbranch_scc1 L_pt_42
    v_lshlrev_b32 v7, 4, v1
    s_cmp_lg_u32 s24, 7
    s_cbranch_scc1 L_pt7_43
    s_mul_i32 s37, s36, 7296
    s_add_u32 s37, s37, 0x9a000
    buffer_load_dwordx4 v[88:91], v7, s[12:15], s37 offen sc1
    s_add_u32 s37, s37, 1024
    buffer_load_dwordx4 v[88:91], v7, s[12:15], s37 offen sc1
    s_add_u32 s37, s37, 1024
    buffer_load_dwordx4 v[88:91], v7, s[12:15], s37 offen sc1
    s_add_u32 s37, s37, 1024
    buffer_load_dwordx4 v[88:91], v7, s[12:15], s37 offen sc1
    s_add_u32 s37, s37, 1024
    buffer_load_dwordx4 v[88:91], v7, s[12:15], s37 offen sc1
    s_add_u32 s37, s37, 1024
    buffer_load_dwordx4 v[88:91], v7, s[12:15], s37 offen sc1
    s_add_u32 s37, s37, 1024
    buffer_load_dwordx4 v[88:91], v7, s[12:15], s37 offen sc1
    s_add_u32 s37, s37, 1024
L_pt7_43:
    s_cmp_lg_u32 s24, 5
    s_cbranch_scc1 L_pt5_44
    s_mov_b32 s37, 0x98000
    buffer_load_dwordx4 v[88:91], v7, s[12:15], s37 offen sc1
    buffer_load_dwordx4 v[88:91], v7, s[12:15], s37 offen offset:1024 sc1
L_pt5_44:
    s_cmp_lg_u32 s24, 6
    s_cbranch_scc1 L_pt6_45
    s_mul_i32 s37, s36, 4224
    s_add_u32 s37, s37, 0x100000
    buffer_load_dwordx4 v[88:91], v7, s[12:15], s37 offen sc1
    s_add_u32 s37, s37, 1024
    buffer_load_dwordx4 v[88:91], v7, s[12:15], s37 offen sc1
    s_add_u32 s37, s37, 1024
    buffer_load_dwordx4 v[88:91], v7, s[12:15], s37 offen sc1
    s_add_u32 s37, s37, 1024
    buffer_load_dwordx4 v[88:91], v7, s[12:15], s37 offen sc1
    s_add_u32 s37, s37, 1024
L_pt6_45:
L_pt_42:
    s_cmp_lt_u32 s35, 2
    s_cbranch_scc1 L_noffn_46
    s_cmp_eq_u32 s24, 5
    s_cselect_b32 s37, 1, 0
    s_cmp_eq_u32 s24, 6
    s_cselect_b32 s37, 1, s37
    s_cmp_eq_u32 s37, 0
    s_cbranch_scc1 L_noffn_46
    v_lshlrev_b32 v7, 4, v1
    s_mul_i32 s37, s24, 7168
    v_add_u32 v7, s37, v7
    ds_read_b128 v[160:163], v7 offset:32768
    ds_read_b128 v[164:167], v7 offset:33792
    ds_read_b128 v[168:171], v7 offset:34816
    ds_read_b128 v[172:175], v7 offset:35840
    ds_read_b128 v[176:179], v7 offset:36864
    ds_read_b128 v[180:183], v7 offset:37888
    ds_read_b128 v[184:187], v7 offset:38912
    v_mov_b32 v188, 0
    v_mov_b32 v189, 0
    v_mov_b32 v190, 0
    v_mov_b32 v191, 0
    s_and_b32 s37, s24, 3
    s_lshl_b32 s37, s37, 8
    s_lshr_b32 s38, s24, 2
    s_lshl_b32 s38, s38, 15
    s_add_u32 s37, s37, s38
    s_add_u32 s37, s37, 90112
    v_lshlrev_b32 v8, 2, v1
    v_add_u32 v8, s37, v8
    ds_read2st64_b32 v[192:193], v8 offset0:0 offset1:4
    ds_read2st64_b32 v[194:195], v8 offset0:8 offset1:12
    ds_read2st64_b32 v[196:197], v8 offset0:16 offset1:20
    ds_read2st64_b32 v[198:199], v8 offset0:24 offset1:28
    ds_read2st64_b32 v[200:201], v8 offset0:32 offset1:36
    ds_read2st64_b32 v[202:203], v8 offset0:40 offset1:44
    ds_read2st64_b32 v[204:205], v8 offset0:48 offset1:52
    ds_read2st64_b32 v[206:207], v8 offset0:56 offset1:60
    ds_read2st64_b32 v[208:209], v8 offset0:64 offset1:68
    ds_read2st64_b32 v[210:211], v8 offset0:72 offset1:76
    ds_read2st64_b32 v[212:213], v8 offset0:80 offset1:84
    ds_read2st64_b32 v[214:215], v8 offset0:88 offset1:92
    ds_read2st64_b32 v[216:217], v8 offset0:96 offset1:100
    ds_read2st64_b32 v[218:219], v8 offset0:104 offset1:108
    ds_read2st64_b32 v[220:221], v8 offset0:112 offset1:116
    ds_read2st64_b32 v[222:223], v8 offset0:120 offset1:124
    v_lshlrev_b32 v64, 16, v64
    v_lshlrev_b32 v65, 16, v65
    v_lshlrev_b32 v66, 16, v66
    v_lshlrev_b32 v32, 2, v1
    v_add_u32 v32, 0, v32
    s_movk_i32 s37, 1171
    v_mul_u32_u24 v9, s37, v32
    v_lshrrev_b32 v9, 16, v9
    v_mul_u32_u24 v10, 56, v9
    v_sub_u32 v10, v32, v10
    v_lshrrev_b32 v11, 4, v10
    v_lshl_add_u32 v9, v9, 2, v11
    v_and_b32 v11, 7, v10
    v_lshl_add_u32 v9, v9, 3, v11
    v_bfe_u32 v11, v10, 3, 1
    v_lshlrev_b32 v11, 1, v11
    v_lshl_add_u32 v32, v9, 2, v11
    v_lshlrev_b32 v33, 2, v1
    v_add_u32 v33, 1, v33
    s_movk_i32 s37, 1171
    v_mul_u32_u24 v9, s37, v33
    v_lshrrev_b32 v9, 16, v9
    v_mul_u32_u24 v10, 56, v9
    v_sub_u32 v10, v33, v10
    v_lshrrev_b32 v11, 4, v10
    v_lshl_add_u32 v9, v9, 2, v11
    v_and_b32 v11, 7, v10
    v_lshl_add_u32 v9, v9, 3, v11
    v_bfe_u32 v11, v10, 3, 1
    v_lshlrev_b32 v11, 1, v11
    v_lshl_add_u32 v33, v9, 2, v11
    v_lshlrev_b32 v34, 2, v1
    v_add_u32 v34, 2, v34
    s_movk_i32 s37, 1171
    v_mul_u32_u24 v9, s37, v34
    v_lshrrev_b32 v9, 16, v9
    v_mul_u32_u24 v10, 56, v9
    v_sub_u32 v10, v34, v10
    v_lshrrev_b32 v11, 4, v10
    v_lshl_add_u32 v9, v9, 2, v11
    v_and_b32 v11, 7, v10
    v_lshl_add_u32 v9, v9, 3, v11
    v_bfe_u32 v11, v10, 3, 1
    v_lshlrev_b32 v11, 1, v11
    v_lshl_add_u32 v34, v9, 2, v11
    v_lshlrev_b32 v35, 2, v1
    v_add_u32 v35, 3, v35
    s_movk_i32 s37, 1171
    v_mul_u32_u24 v9, s37, v35
    v_lshrrev_b32 v9, 16, v9
    v_mul_u32_u24 v10, 56, v9
    v_sub_u32 v10, v35, v10
    v_lshrrev_b32 v11, 4, v10
    v_lshl_add_u32 v9, v9, 2, v11
    v_and_b32 v11, 7, v10
    v_lshl_add_u32 v9, v9, 3, v11
    v_bfe_u32 v11, v10, 3, 1
    v_lshlrev_b32 v11, 1, v11
    v_lshl_add_u32 v35, v9, 2, v11
    v_lshlrev_b32 v36, 2, v1
    v_add_u32 v36, 224, v36
    s_movk_i32 s37, 1171
    v_mul_u32_u24 v9, s37, v36
    v_lshrrev_b32 v9, 16, v9
    v_mul_u32_u24 v10, 56, v9
    v_sub_u32 v10, v36, v10
    v_lshrrev_b32 v11, 4, v10
    v_lshl_add_u32 v9, v9, 2, v11
    v_and_b32 v11, 7, v10
    v_lshl_add_u32 v9, v9, 3, v11
    v_bfe_u32 v11, v10, 3, 1
    v_lshlrev_b32 v11, 1, v11
    v_lshl_add_u32 v36, v9, 2, v11
    v_lshlrev_b32 v37, 2, v1
    v_add_u32 v37, 225, v37
    s_movk_i32 s37, 1171
    v_mul_u32_u24 v9, s37, v37
    v_lshrrev_b32 v9, 16, v9
    v_mul_u32_u24 v10, 56, v9
    v_sub_u32 v10, v37, v10
    v_lshrrev_b32 v11, 4, v10
    v_lshl_add_u32 v9, v9, 2, v11
    v_and_b32 v11, 7, v10
    v_lshl_add_u32 v9, v9, 3, v11
    v_bfe_u32 v11, v10, 3, 1
    v_lshlrev_b32 v11, 1, v11
    v_lshl_add_u32 v37, v9, 2, v11
    v_lshlrev_b32 v38, 2, v1
    v_add_u32 v38, 226, v38
    s_movk_i32 s37, 1171
    v_mul_u32_u24 v9, s37, v38
    v_lshrrev_b32 v9, 16, v9
    v_mul_u32_u24 v10, 56, v9
    v_sub_u32 v10, v38, v10
    v_lshrrev_b32 v11, 4, v10
    v_lshl_add_u32 v9, v9, 2, v11
    v_and_b32 v11, 7, v10
    v_lshl_add_u32 v9, v9, 3, v11
    v_bfe_u32 v11, v10, 3, 1
    v_lshlrev_b32 v11, 1, v11
    v_lshl_add_u32 v38, v9, 2, v11
    v_lshlrev_b32 v39, 2, v1
    v_add_u32 v39, 227, v39
    s_movk_i32 s37, 1171
    v_mul_u32_u24 v9, s37, v39
    v_lshrrev_b32 v9, 16, v9
    v_mul_u32_u24 v10, 56, v9
    v_sub_u32 v10, v39, v10
    v_lshrrev_b32 v11, 4, v10
    v_lshl_add_u32 v9, v9, 2, v11
    v_and_b32 v11, 7, v10
    v_lshl_add_u32 v9, v9, 3, v11
    v_bfe_u32 v11, v10, 3, 1
    v_lshlrev_b32 v11, 1, v11
    v_lshl_add_u32 v39, v9, 2, v11
    s_waitcnt lgkmcnt(0)
    v_perm_b32 v9, v164, v160, s41
    v_perm_b32 v164, v164, v160, s42
    v_mov_b32 v160, v9
    v_perm_b32 v9, v165, v161, s41
    v_perm_b32 v165, v165, v161, s42
    v_mov_b32 v161, v9
    v_perm_b32 v9, v166, v162, s41
    v_perm_b32 v166, v166, v162, s42
    v_mov_b32 v162, v9
    v_perm_b32 v9, v167, v163, s41
    v_perm_b32 v167, v167, v163, s42
    v_mov_b32 v163, v9
    v_perm_b32 v9, v172, v168, s41
    v_perm_b32 v172, v172, v168, s42
    v_mov_b32 v168, v9
    v_perm_b32 v9, v173, v169, s41
    v_perm_b32 v173, v173, v169, s42
    v_mov_b32 v169, v9
    v_perm_b32 v9, v174, v170, s41
    v_perm_b32 v174, v174, v170, s42
    v_mov_b32 v170, v9
    v_perm_b32 v9, v175, v171, s41
    v_perm_b32 v175, v175, v171, s42
    v_mov_b32 v171, v9
    v_perm_b32 v9, v180, v176, s41
    v_perm_b32 v180, v180, v176, s42
    v_mov_b32 v176, v9
    v_perm_b32 v9, v181, v177, s41
    v_perm_b32 v181, v181, v177, s42
    v_mov_b32 v177, v9
    v_perm_b32 v9, v182, v178, s41
    v_perm_b32 v182, v182, v178, s42
    v_mov_b32 v178, v9
    v_perm_b32 v9, v183, v179, s41
    v_perm_b32 v183, v183, v179, s42
    v_mov_b32 v179, v9
    v_perm_b32 v9, v188, v184, s41
    v_perm_b32 v188, v188, v184, s42
    v_mov_b32 v184, v9
    v_perm_b32 v9, v189, v185, s41
    v_perm_b32 v189, v189, v185, s42
    v_mov_b32 v185, v9
    v_perm_b32 v9, v190, v186, s41
    v_perm_b32 v190, v190, v186, s42
    v_mov_b32 v186, v9
    v_perm_b32 v9, v191, v187, s41
    v_perm_b32 v191, v191, v187, s42
    v_mov_b32 v187, v9
    v_perm_b32 v9, v193, v192, s41
    v_perm_b32 v193, v193, v192, s42
    v_mov_b32 v192, v9
    v_perm_b32 v9, v195, v194, s41
    v_perm_b32 v195, v195, v194, s42
    v_mov_b32 v194, v9
    v_perm_b32 v9, v197, v196, s41
    v_perm_b32 v197, v197, v196, s42
    v_mov_b32 v196, v9
    v_perm_b32 v9, v199, v198, s41
    v_perm_b32 v199, v199, v198, s42
    v_mov_b32 v198, v9
    v_perm_b32 v9, v201, v200, s41
    v_perm_b32 v201, v201, v200, s42
    v_mov_b32 v200, v9
    v_perm_b32 v9, v203, v202, s41
    v_perm_b32 v203, v203, v202, s42
    v_mov_b32 v202, v9
    v_perm_b32 v9, v205, v204, s41
    v_perm_b32 v205, v205, v204, s42
    v_mov_b32 v204, v9
    v_perm_b32 v9, v207, v206, s41
    v_perm_b32 v207, v207, v206, s42
    v_mov_b32 v206, v9
    v_perm_b32 v9, v209, v208, s41
    v_perm_b32 v209, v209, v208, s42
    v_mov_b32 v208, v9
    v_perm_b32 v9, v211, v210, s41
    v_perm_b32 v211, v211, v210, s42
    v_mov_b32 v210, v9
    v_perm_b32 v9, v213, v212, s41
    v_perm_b32 v213, v213, v212, s42
    v_mov_b32 v212, v9
    v_perm_b32 v9, v215, v214, s41
    v_perm_b32 v215, v215, v214, s42
    v_mov_b32 v214, v9
    v_perm_b32 v9, v217, v216, s41
    v_perm_b32 v217, v217, v216, s42
    v_mov_b32 v216, v9
    v_perm_b32 v9, v219, v218, s41
    v_perm_b32 v219, v219, v218, s42
    v_mov_b32 v218, v9
    v_perm_b32 v9, v221, v220, s41
    v_perm_b32 v221, v221, v220, s42
    v_mov_b32 v220, v9
    v_perm_b32 v9, v223, v222, s41
    v_perm_b32 v223, v223, v222, s42
    v_mov_b32 v222, v9
    s_and_b32 s37, s24, 3
    s_lshl_b32 s37, s37, 6
    v_add_u32 v49, s37, v1
    v_lshrrev_b32 v48, 3, v49
    s_movk_i32 s38, 7296
    v_mul_lo_u32 v48, v48, s38
    v_and_b32 v9, 7, v49
    v_lshlrev_b32 v9, 4, v9
    v_add_u32 v48, v48, v9
    s_lshl_b32 s37, s36, 1
    s_lshr_b32 s38, s24, 2
    s_add_u32 s37, s37, s38
    s_lshl_b32 s37, s37, 7
    s_add_u32 s37, s37, 0x9a000
    v_add_u32 v48, s37, v48
L_noffn_46:
    v_lshrrev_b32 v51, 3, v0
    s_movk_i32 s38, 4224
    v_mul_lo_u32 v51, v51, s38
    v_and_b32 v9, 7, v0
    v_lshlrev_b32 v9, 4, v9
    v_add_u32 v51, v51, v9
    s_lshl_b32 s37, s36, 7
    s_add_u32 s37, s37, 0x100000
    v_add_u32 v51, s37, v51
    v_mov_b32 v40, 0
    v_mov_b32 v41, 0
    v_mov_b32 v42, 0
    v_mov_b32 v43, 0
    v_mov_b32 v44, 0
    v_mov_b32 v45, 0
    v_mov_b32 v46, 0
    v_mov_b32 v47, 0
    v_lshlrev_b32 v52, 5, v1
    s_mul_i32 s37, s24, 1792
    v_add_u32 v52, s37, v52
    s_mov_b32 s49, 3
    s_branch L_spchk_49
L_sp_47:
    s_bitcmp1_b32 s49, 0
    s_cbranch_scc0 L_sk_50
    buffer_load_dwordx4 v[232:235], v50, s[12:15], 0 offen sc1
L_sk_50:
    s_bitcmp1_b32 s49, 1
    s_cbranch_scc0 L_sk_51
    buffer_load_dwordx4 v[236:239], v50, s[12:15], 0 offen offset:1024 sc1
L_sk_51:
L_spchk_49:
    s_waitcnt vmcnt(0)
    s_bitcmp1_b32 s49, 0
    s_cbranch_scc0 L_sc_52
    v_cmp_ne_u32 vcc, s27, v235
    s_cbranch_vccnz L_sc_52
    s_bitset0_b32 s49, 0
L_sc_52:
    s_bitcmp1_b32 s49, 1
    s_cbranch_scc0 L_sc_53
    v_cmp_ne_u32 vcc, s27, v239
    s_cbranch_vccnz L_sc_53
    s_bitset0_b32 s49, 1
L_sc_53:
    s_cmp_eq_u32 s49, 0
    s_cbranch_scc1 L_spok_48
    s_sub_u32 s30, s30, 1
    s_cbranch_scc0 L_sp_47
    s_mov_b32 s30, 0
L_spok_48:
    v_mov_b32_dpp v224, v234 row_newbcast:0 row_mask:0xf bank_mask:0x3
    v_mov_b32_dpp v228, v238 row_newbcast:0 row_mask:0xf bank_mask:0x3
    v_mov_b32_dpp v225, v234 row_newbcast:1 row_mask:0xf bank_mask:0x3
    v_mov_b32_dpp v229, v238 row_newbcast:1 row_mask:0xf bank_mask:0x3
    v_mov_b32_dpp v224, v234 row_newbcast:8 row_mask:0xf bank_mask:0xc
    v_mov_b32_dpp v228, v238 row_newbcast:8 row_mask:0xf bank_mask:0xc
    v_mov_b32_dpp v225, v234 row_newbcast:9 row_mask:0xf bank_mask:0xc
    v_mov_b32_dpp v229, v238 row_newbcast:9 row_mask:0xf bank_mask:0xc
    v_max_f32 v9, v224, v228
    s_nop 1
    v_max_f32_dpp v9, v9, v9 row_ror:8 row_mask:0xf bank_mask:0xf
    v_mov_b32 v10, v9
    s_nop 1
    v_permlane16_swap_b32 v9, v10
    s_nop 0
    v_max_f32 v9, v9, v10
    v_mov_b32 v10, v9
    s_nop 1
    v_permlane32_swap_b32 v9, v10
    s_nop 0
    v_max_f32 v9, v9, v10
    s_nop 1
    v_sub_f32 v224, v224, v9
    v_sub_f32 v228, v228, v9
    v_mul_f32 v224, s33, v224
    v_mul_f32 v228, s33, v228
    v_exp_f32 v224, v224
    v_exp_f32 v228, v228
    s_nop 0
    v_mul_f32 v240, v224, v225
    v_mul_f32 v241, v224, v232
    v_mul_f32 v242, v224, v233
    v_fmac_f32 v240, v228, v229
    v_fmac_f32 v241, v228, v236
    v_fmac_f32 v242, v228, v237
    s_nop 1
    v_add_f32_dpp v240, v240, v240 row_ror:8 row_mask:0xf bank_mask:0xf
    v_add_f32_dpp v241, v241, v241 row_ror:8 row_mask:0xf bank_mask:0xf
    v_add_f32_dpp v242, v242, v242 row_ror:8 row_mask:0xf bank_mask:0xf
    v_mov_b32 v243, v240
    v_mov_b32 v244, v241
    v_mov_b32 v245, v242
    v_permlane16_swap_b32 v240, v243
    v_permlane16_swap_b32 v241, v244
    v_permlane16_swap_b32 v242, v245
    s_nop 0
    v_add_f32 v240, v240, v243
    v_add_f32 v241, v241, v244
    v_add_f32 v242, v242, v245
    v_mov_b32 v243, v240
    v_mov_b32 v244, v241
    v_mov_b32 v245, v242
    v_permlane32_swap_b32 v240, v243
    v_permlane32_swap_b32 v241, v244
    v_permlane32_swap_b32 v242, v245
    s_nop 0
    v_add_f32 v240, v240, v243
    v_add_f32 v241, v241, v244
    v_add_f32 v242, v242, v245
    s_nop 1
    v_rcp_f32 v240, v240
    s_nop 0
    v_mul_f32 v241, v241, v240
    v_mul_f32 v242, v242, v240
    v_cvt_pk_bf16_f32 v244, v241, v242
    s_nop 0
    v_readlane_b32 s64, v244, 0
    v_readlane_b32 s65, v244, 1
    v_readlane_b32 s66, v244, 2
    v_readlane_b32 s67, v244, 3
    v_readlane_b32 s68, v244, 4
    v_readlane_b32 s69, v244, 5
    v_readlane_b32 s70, v244, 6
    v_readlane_b32 s71, v244, 7
    s_nop 0
    v_dot2c_f32_bf16 v40, s64, v96
    v_dot2c_f32_bf16 v41, s64, v100
    v_dot2c_f32_bf16 v42, s64, v97
    v_dot2c_f32_bf16 v43, s64, v101
    v_dot2c_f32_bf16 v44, s64, v98
    v_dot2c_f32_bf16 v45, s64, v102
    v_dot2c_f32_bf16 v46, s64, v99
    v_dot2c_f32_bf16 v47, s64, v103
    v_dot2c_f32_bf16 v40, s65, v104
    v_dot2c_f32_bf16 v41, s65, v108
    v_dot2c_f32_bf16 v42, s65, v105
    v_dot2c_f32_bf16 v43, s65, v109
    v_dot2c_f32_bf16 v44, s65, v106
    v_dot2c_f32_bf16 v45, s65, v110
    v_dot2c_f32_bf16 v46, s65, v107
    v_dot2c_f32_bf16 v47, s65, v111
    v_dot2c_f32_bf16 v40, s66, v112
    v_dot2c_f32_bf16 v41, s66, v116
    v_dot2c_f32_bf16 v42, s66, v113
    v_dot2c_f32_bf16 v43, s66, v117
    v_dot2c_f32_bf16 v44, s66, v114
    v_dot2c_f32_bf16 v45, s66, v118
    v_dot2c_f32_bf16 v46, s66, v115
    v_dot2c_f32_bf16 v47, s66, v119
    v_dot2c_f32_bf16 v40, s67, v120
    v_dot2c_f32_bf16 v41, s67, v124
    v_dot2c_f32_bf16 v42, s67, v121
    v_dot2c_f32_bf16 v43, s67, v125
    v_dot2c_f32_bf16 v44, s67, v122
    v_dot2c_f32_bf16 v45, s67, v126
    v_dot2c_f32_bf16 v46, s67, v123
    v_dot2c_f32_bf16 v47, s67, v127
    v_dot2c_f32_bf16 v40, s68, v128
    v_dot2c_f32_bf16 v41, s68, v132
    v_dot2c_f32_bf16 v42, s68, v129
    v_dot2c_f32_bf16 v43, s68, v133
    v_dot2c_f32_bf16 v44, s68, v130
    v_dot2c_f32_bf16 v45, s68, v134
    v_dot2c_f32_bf16 v46, s68, v131
    v_dot2c_f32_bf16 v47, s68, v135
    v_dot2c_f32_bf16 v40, s69, v136
    v_dot2c_f32_bf16 v41, s69, v140
    v_dot2c_f32_bf16 v42, s69, v137
    v_dot2c_f32_bf16 v43, s69, v141
    v_dot2c_f32_bf16 v44, s69, v138
    v_dot2c_f32_bf16 v45, s69, v142
    v_dot2c_f32_bf16 v46, s69, v139
    v_dot2c_f32_bf16 v47, s69, v143
    v_dot2c_f32_bf16 v40, s70, v144
    v_dot2c_f32_bf16 v41, s70, v148
    v_dot2c_f32_bf16 v42, s70, v145
    v_dot2c_f32_bf16 v43, s70, v149
    v_dot2c_f32_bf16 v44, s70, v146
    v_dot2c_f32_bf16 v45, s70, v150
    v_dot2c_f32_bf16 v46, s70, v147
    v_dot2c_f32_bf16 v47, s70, v151
    v_dot2c_f32_bf16 v40, s71, v152
    v_dot2c_f32_bf16 v41, s71, v156
    v_dot2c_f32_bf16 v42, s71, v153
    v_dot2c_f32_bf16 v43, s71, v157
    v_dot2c_f32_bf16 v44, s71, v154
    v_dot2c_f32_bf16 v45, s71, v158
    v_dot2c_f32_bf16 v46, s71, v155
    v_dot2c_f32_bf16 v47, s71, v159
    s_mov_b32 exec_lo, -1
    s_mov_b32 exec_hi, 0x00ffffff
    s_nop 1
    ds_write_b128 v52, v[40:43] offset:16384
    ds_write_b128 v52, v[44:47] offset:16400
    s_mov_b64 exec, -1
    s_waitcnt lgkmcnt(0)
    s_barrier
    s_cmp_gt_u32 s24, 3
    s_cbranch_scc1 L_ysent
    v_lshlrev_b32 v8, 3, v0
    ds_read_b64 v[224:225], v8 offset:16384
    ds_read_b64 v[226:227], v8 offset:18176
    ds_read_b64 v[228:229], v8 offset:19968
    ds_read_b64 v[230:231], v8 offset:21760
    ds_read_b64 v[232:233], v8 offset:23552
    ds_read_b64 v[234:235], v8 offset:25344
    ds_read_b64 v[236:237], v8 offset:27136
    ds_read_b64 v[238:239], v8 offset:28928
    v_mov_b32 v242, 0
    v_mov_b32 v243, s27
    v_cmp_gt_u32 vcc, 224, v0
    s_waitcnt lgkmcnt(0)
    v_pk_add_f32 v[224:225], v[224:225], v[232:233]
    v_pk_add_f32 v[226:227], v[226:227], v[234:235]
    v_pk_add_f32 v[228:229], v[228:229], v[236:237]
    v_pk_add_f32 v[230:231], v[230:231], v[238:239]
    v_pk_add_f32 v[224:225], v[224:225], v[228:229]
    v_pk_add_f32 v[226:227], v[226:227], v[230:231]
    v_pk_add_f32 v[224:225], v[224:225], v[226:227]
    v_mov_b32 v240, v224
    v_mov_b32 v241, v225
    s_and_saveexec_b64 s[50:51], vcc
    s_cmp_eq_u32 s57, 0
    s_cbranch_scc1 L_ls_54
    buffer_store_dwordx4 v[240:243], v51, s[12:15], 0 offen
    s_branch L_ls_55
L_ls_54:
    buffer_store_dwordx4 v[240:243], v51, s[12:15], 0 offen sc1
L_ls_55:
    s_mov_b64 exec, -1
L_ysent:
    s_cmp_lt_u32 s35, 2
    s_cbranch_scc1 L_end
    s_cmp_eq_u32 s24, 5
    s_cbranch_scc1 L_a_ln
    s_cmp_eq_u32 s24, 6
    s_cbranch_scc1 L_yred
    v_lshlrev_b32 v7, 4, v1
    s_mul_i32 s37, s24, 7168
    v_add_u32 v7, s37, v7
    ds_read_b128 v[160:163], v7 offset:32768
    ds_read_b128 v[164:167], v7 offset:33792
    ds_read_b128 v[168:171], v7 offset:34816
    ds_read_b128 v[172:175], v7 offset:35840
    ds_read_b128 v[176:179], v7 offset:36864
    ds_read_b128 v[180:183], v7 offset:37888
    ds_read_b128 v[184:187], v7 offset:38912
    v_mov_b32 v188, 0
    v_mov_b32 v189, 0
    v_mov_b32 v190, 0
    v_mov_b32 v191, 0
    s_and_b32 s37, s24, 3
    s_lshl_b32 s37, s37, 8
    s_lshr_b32 s38, s24, 2
    s_lshl_b32 s38, s38, 15
    s_add_u32 s37, s37, s38
    s_add_u32 s37, s37, 90112
    v_lshlrev_b32 v8, 2, v1
    v_add_u32 v8, s37, v8
    ds_read2st64_b32 v[192:193], v8 offset0:0 offset1:4
    ds_read2st64_b32 v[194:195], v8 offset0:8 offset1:12
    ds_read2st64_b32 v[196:197], v8 offset0:16 offset1:20
    ds_read2st64_b32 v[198:199], v8 offset0:24 offset1:28
    ds_read2st64_b32 v[200:201], v8 offset0:32 offset1:36
    ds_read2st64_b32 v[202:203], v8 offset0:40 offset1:44
    ds_read2st64_b32 v[204:205], v8 offset0:48 offset1:52
    ds_read2st64_b32 v[206:207], v8 offset0:56 offset1:60
    ds_read2st64_b32 v[208:209], v8 offset0:64 offset1:68
    ds_read2st64_b32 v[210:211], v8 offset0:72 offset1:76
    ds_read2st64_b32 v[212:213], v8 offset0:80 offset1:84
    ds_read2st64_b32 v[214:215], v8 offset0:88 offset1:92
    ds_read2st64_b32 v[216:217], v8 offset0:96 offset1:100
    ds_read2st64_b32 v[218:219], v8 offset0:104 offset1:108
    ds_read2st64_b32 v[220:221], v8 offset0:112 offset1:116
    ds_read2st64_b32 v[222:223], v8 offset0:120 offset1:124
    v_lshlrev_b32 v64, 16, v64
    v_lshlrev_b32 v65, 16, v65
    v_lshlrev_b32 v66, 16, v66
    v_lshlrev_b32 v32, 2, v1
    v_add_u32 v32, 0, v32
    s_movk_i32 s37, 1171
    v_mul_u32_u24 v9, s37, v32
    v_lshrrev_b32 v9, 16, v9
    v_mul_u32_u24 v10, 56, v9
    v_sub_u32 v10, v32, v10
    v_lshrrev_b32 v11, 4, v10
    v_lshl_add_u32 v9, v9, 2, v11
    v_and_b32 v11, 7, v10
    v_lshl_add_u32 v9, v9, 3, v11
    v_bfe_u32 v11, v10, 3, 1
    v_lshlrev_b32 v11, 1, v11
    v_lshl_add_u32 v32, v9, 2, v11
    v_lshlrev_b32 v33, 2, v1
    v_add_u32 v33, 1, v33
    s_movk_i32 s37, 1171
    v_mul_u32_u24 v9, s37, v33
    v_lshrrev_b32 v9, 16, v9
    v_mul_u32_u24 v10, 56, v9
    v_sub_u32 v10, v33, v10
    v_lshrrev_b32 v11, 4, v10
    v_lshl_add_u32 v9, v9, 2, v11
    v_and_b32 v11, 7, v10
    v_lshl_add_u32 v9, v9, 3, v11
    v_bfe_u32 v11, v10, 3, 1
    v_lshlrev_b32 v11, 1, v11
    v_lshl_add_u32 v33, v9, 2, v11
    v_lshlrev_b32 v34, 2, v1
    v_add_u32 v34, 2, v34
    s_movk_i32 s37, 1171
    v_mul_u32_u24 v9, s37, v34
    v_lshrrev_b32 v9, 16, v9
    v_mul_u32_u24 v10, 56, v9
    v_sub_u32 v10, v34, v10
    v_lshrrev_b32 v11, 4, v10
    v_lshl_add_u32 v9, v9, 2, v11
    v_and_b32 v11, 7, v10
    v_lshl_add_u32 v9, v9, 3, v11
    v_bfe_u32 v11, v10, 3, 1
    v_lshlrev_b32 v11, 1, v11
    v_lshl_add_u32 v34, v9, 2, v11
    v_lshlrev_b32 v35, 2, v1
    v_add_u32 v35, 3, v35
    s_movk_i32 s37, 1171
    v_mul_u32_u24 v9, s37, v35
    v_lshrrev_b32 v9, 16, v9
    v_mul_u32_u24 v10, 56, v9
    v_sub_u32 v10, v35, v10
    v_lshrrev_b32 v11, 4, v10
    v_lshl_add_u32 v9, v9, 2, v11
    v_and_b32 v11, 7, v10
    v_lshl_add_u32 v9, v9, 3, v11
    v_bfe_u32 v11, v10, 3, 1
    v_lshlrev_b32 v11, 1, v11
    v_lshl_add_u32 v35, v9, 2, v11
    v_lshlrev_b32 v36, 2, v1
    v_add_u32 v36, 224, v36
    s_movk_i32 s37, 1171
    v_mul_u32_u24 v9, s37, v36
    v_lshrrev_b32 v9, 16, v9
    v_mul_u32_u24 v10, 56, v9
    v_sub_u32 v10, v36, v10
    v_lshrrev_b32 v11, 4, v10
    v_lshl_add_u32 v9, v9, 2, v11
    v_and_b32 v11, 7, v10
    v_lshl_add_u32 v9, v9, 3, v11
    v_bfe_u32 v11, v10, 3, 1
    v_lshlrev_b32 v11, 1, v11
    v_lshl_add_u32 v36, v9, 2, v11
    v_lshlrev_b32 v37, 2, v1
    v_add_u32 v37, 225, v37
    s_movk_i32 s37, 1171
    v_mul_u32_u24 v9, s37, v37
    v_lshrrev_b32 v9, 16, v9
    v_mul_u32_u24 v10, 56, v9
    v_sub_u32 v10, v37, v10
    v_lshrrev_b32 v11, 4, v10
    v_lshl_add_u32 v9, v9, 2, v11
    v_and_b32 v11, 7, v10
    v_lshl_add_u32 v9, v9, 3, v11
    v_bfe_u32 v11, v10, 3, 1
    v_lshlrev_b32 v11, 1, v11
    v_lshl_add_u32 v37, v9, 2, v11
    v_lshlrev_b32 v38, 2, v1
    v_add_u32 v38, 226, v38
    s_movk_i32 s37, 1171
    v_mul_u32_u24 v9, s37, v38
    v_lshrrev_b32 v9, 16, v9
    v_mul_u32_u24 v10, 56, v9
    v_sub_u32 v10, v38, v10
    v_lshrrev_b32 v11, 4, v10
    v_lshl_add_u32 v9, v9, 2, v11
    v_and_b32 v11, 7, v10
    v_lshl_add_u32 v9, v9, 3, v11
    v_bfe_u32 v11, v10, 3, 1
    v_lshlrev_b32 v11, 1, v11
    v_lshl_add_u32 v38, v9, 2, v11
    v_lshlrev_b32 v39, 2, v1
    v_add_u32 v39, 227, v39
    s_movk_i32 s37, 1171
    v_mul_u32_u24 v9, s37, v39
    v_lshrrev_b32 v9, 16, v9
    v_mul_u32_u24 v10, 56, v9
    v_sub_u32 v10, v39, v10
    v_lshrrev_b32 v11, 4, v10
    v_lshl_add_u32 v9, v9, 2, v11
    v_and_b32 v11, 7, v10
    v_lshl_add_u32 v9, v9, 3, v11
    v_bfe_u32 v11, v10, 3, 1
    v_lshlrev_b32 v11, 1, v11
    v_lshl_add_u32 v39, v9, 2, v11
    s_waitcnt lgkmcnt(0)
    v_perm_b32 v9, v164, v160, s41
    v_perm_b32 v164, v164, v160, s42
    v_mov_b32 v160, v9
    v_perm_b32 v9, v165, v161, s41
    v_perm_b32 v165, v165, v161, s42
    v_mov_b32 v161, v9
    v_perm_b32 v9, v166, v162, s41
    v_perm_b32 v166, v166, v162, s42
    v_mov_b32 v162, v9
    v_perm_b32 v9, v167, v163, s41
    v_perm_b32 v167, v167, v163, s42
    v_mov_b32 v163, v9
    v_perm_b32 v9, v172, v168, s41
    v_perm_b32 v172, v172, v168, s42
    v_mov_b32 v168, v9
    v_perm_b32 v9, v173, v169, s41
    v_perm_b32 v173, v173, v169, s42
    v_mov_b32 v169, v9
    v_perm_b32 v9, v174, v170, s41
    v_perm_b32 v174, v174, v170, s42
    v_mov_b32 v170, v9
    v_perm_b32 v9, v175, v171, s41
    v_perm_b32 v175, v175, v171, s42
    v_mov_b32 v171, v9
    v_perm_b32 v9, v180, v176, s41
    v_perm_b32 v180, v180, v176, s42
    v_mov_b32 v176, v9
    v_perm_b32 v9, v181, v177, s41
    v_perm_b32 v181, v181, v177, s42
    v_mov_b32 v177, v9
    v_perm_b32 v9, v182, v178, s41
    v_perm_b32 v182, v182, v178, s42
    v_mov_b32 v178, v9
    v_perm_b32 v9, v183, v179, s41
    v_perm_b32 v183, v183, v179, s42
    v_mov_b32 v179, v9
    v_perm_b32 v9, v188, v184, s41
    v_perm_b32 v188, v188, v184, s42
    v_mov_b32 v184, v9
    v_perm_b32 v9, v189, v185, s41
    v_perm_b32 v189, v189, v185, s42
    v_mov_b32 v185, v9
    v_perm_b32 v9, v190, v186, s41
    v_perm_b32 v190, v190, v186, s42
    v_mov_b32 v186, v9
    v_perm_b32 v9, v191, v187, s41
    v_perm_b32 v191, v191, v187, s42
    v_mov_b32 v187, v9
    v_perm_b32 v9, v193, v192, s41
    v_perm_b32 v193, v193, v192, s42
    v_mov_b32 v192, v9
    v_perm_b32 v9, v195, v194, s41
    v_perm_b32 v195, v195, v194, s42
    v_mov_b32 v194, v9
    v_perm_b32 v9, v197, v196, s41
    v_perm_b32 v197, v197, v196, s42
    v_mov_b32 v196, v9
    v_perm_b32 v9, v199, v198, s41
    v_perm_b32 v199, v199, v198, s42
    v_mov_b32 v198, v9
    v_perm_b32 v9, v201, v200, s41
    v_perm_b32 v201, v201, v200, s42
    v_mov_b32 v200, v9
    v_perm_b32 v9, v203, v202, s41
    v_perm_b32 v203, v203, v202, s42
    v_mov_b32 v202, v9
    v_perm_b32 v9, v205, v204, s41
    v_perm_b32 v205, v205, v204, s42
    v_mov_b32 v204, v9
    v_perm_b32 v9, v207, v206, s41
    v_perm_b32 v207, v207, v206, s42
    v_mov_b32 v206, v9
    v_perm_b32 v9, v209, v208, s41
    v_perm_b32 v209, v209, v208, s42
    v_mov_b32 v208, v9
    v_perm_b32 v9, v211, v210, s41
    v_perm_b32 v211, v211, v210, s42
    v_mov_b32 v210, v9
    v_perm_b32 v9, v213, v212, s41
    v_perm_b32 v213, v213, v212, s42
    v_mov_b32 v212, v9
    v_perm_b32 v9, v215, v214, s41
    v_perm_b32 v215, v215, v214, s42
    v_mov_b32 v214, v9
    v_perm_b32 v9, v217, v216, s41
    v_perm_b32 v217, v217, v216, s42
    v_mov_b32 v216, v9
    v_perm_b32 v9, v219, v218, s41
    v_perm_b32 v219, v219, v218, s42
    v_mov_b32 v218, v9
    v_perm_b32 v9, v221, v220, s41
    v_perm_b32 v221, v221, v220, s42
    v_mov_b32 v220, v9
    v_perm_b32 v9, v223, v222, s41
    v_perm_b32 v223, v223, v222, s42
    v_mov_b32 v222, v9
    s_and_b32 s37, s24, 3
    s_lshl_b32 s37, s37, 6
    v_add_u32 v49, s37, v1
    v_lshrrev_b32 v48, 3, v49
    s_movk_i32 s38, 7296
    v_mul_lo_u32 v48, v48, s38
    v_and_b32 v9, 7, v49
    v_lshlrev_b32 v9, 4, v9
    v_add_u32 v48, v48, v9
    s_lshl_b32 s37, s36, 1
    s_lshr_b32 s38, s24, 2
    s_add_u32 s37, s37, s38
    s_lshl_b32 s37, s37, 7
    s_add_u32 s37, s37, 0x9a000
    v_add_u32 v48, s37, v48
    s_branch L_a_wait
L_yred:
    v_lshlrev_b32 v7, 4, v1
    s_mul_i32 s37, s36, 4224
    s_add_u32 s37, s37, 0x100000
    v_add_u32 v7, s37, v7
    v_and_b32 v8, 7, v1
    v_lshlrev_b32 v8, 1, v8
    v_lshrrev_b32 v11, 5, v1
    v_add_u32 v8, v8, v11
    v_lshlrev_b32 v8, 2, v8
    v_lshlrev_b32 v11, 3, v1
    s_lshl_b32 s46, s36, 6
    s_add_u32 s46, s46, 0x98000
    s_mov_b32 s49, 15
L_sp_56:
    s_bitcmp1_b32 s49, 0
    s_cbranch_scc0 L_sk_59
    buffer_load_dwordx4 v[224:227], v7, s[12:15], 0 offen sc1
L_sk_59:
    s_bitcmp1_b32 s49, 1
    s_cbranch_scc0 L_sk_60
    buffer_load_dwordx4 v[228:231], v7, s[12:15], 0 offen offset:1024 sc1
L_sk_60:
    s_bitcmp1_b32 s49, 2
    s_cbranch_scc0 L_sk_61
    buffer_load_dwordx4 v[232:235], v7, s[12:15], 0 offen offset:2048 sc1
L_sk_61:
    s_bitcmp1_b32 s49, 3
    s_cbranch_scc0 L_sk_62
    buffer_load_dwordx4 v[236:239], v7, s[12:15], 0 offen offset:3072 sc1
L_sk_62:
L_spchk_58:
    s_waitcnt vmcnt(0)
    s_bitcmp1_b32 s49, 0
    s_cbranch_scc0 L_sc_63
    v_cmp_ne_u32 vcc, s27, v227
    s_cbranch_vccnz L_sc_63
    s_bitset0_b32 s49, 0
L_sc_63:
    s_bitcmp1_b32 s49, 1
    s_cbranch_scc0 L_sc_64
    v_cmp_ne_u32 vcc, s27, v231
    s_cbranch_vccnz L_sc_64
    s_bitset0_b32 s49, 1
L_sc_64:
    s_bitcmp1_b32 s49, 2
    s_cbranch_scc0 L_sc_65
    v_cmp_ne_u32 vcc, s27, v235
    s_cbranch_vccnz L_sc_65
    s_bitset0_b32 s49, 2
L_sc_65:
    s_bitcmp1_b32 s49, 3
    s_cbranch_scc0 L_sc_66
    v_cmp_ne_u32 vcc, s27, v239
    s_cbranch_vccnz L_sc_66
    s_bitset0_b32 s49, 3
L_sc_66:
    s_cmp_eq_u32 s49, 0
    s_cbranch_scc1 L_spok_57
    s_sub_u32 s30, s30, 1
    s_cbranch_scc0 L_sp_56
    s_mov_b32 s30, 0
L_spok_57:
    v_pk_add_f32 v[224:225], v[224:225], v[228:229]
    v_pk_add_f32 v[232:233], v[232:233], v[236:237]
    v_pk_add_f32 v[224:225], v[224:225], v[232:233]
    s_nop 1
    v_permlane32_swap_b32 v224, v225
    s_nop 0
    v_add_f32 v224, v224, v225
    v_mov_b32 v9, v224
    s_nop 1
    v_permlane16_swap_b32 v224, v9
    s_nop 0
    v_add_f32 v224, v224, v9
    s_nop 1
    v_add_f32_dpp v224, v224, v224 row_ror:8 row_mask:0xf bank_mask:0xf
    s_nop 0
    v_cvt_pk_bf16_f32 v224, v224, v224
    v_and_b32 v224, 0xffff0000, v224
    v_add_f32 v224, v224, v64
    v_cvt_pk_bf16_f32 v224, v224, v224
    v_and_b32 v224, 0xffff0000, v224
    v_mov_b32 v9, v224
    v_mov_b32 v10, v224
    v_mov_b32 v229, s27
    v_mov_b32 v231, s27
    v_permlane32_swap_b32 v9, v10
    s_nop 0
    v_lshrrev_b32 v228, 16, v9
    v_or_b32 v228, v228, v10
    s_nop 1
    v_mov_b32_dpp v230, v228 quad_perm:[1,0,3,2] row_mask:0xf bank_mask:0xf
    s_mov_b64 exec, 0x55
    s_cmp_eq_u32 s57, 0
    s_cbranch_scc1 L_ls_67
    buffer_store_dwordx4 v[228:231], v11, s[12:15], s46 offen
    s_branch L_ls_68
L_ls_67:
    buffer_store_dwordx4 v[228:231], v11, s[12:15], s46 offen sc1
L_ls_68:
    s_mov_b32 exec_lo, 0xff
    s_mov_b32 exec_hi, 0xff
    ds_write_b32 v8, v224 offset:1536
    s_mov_b64 exec, -1
    s_branch L_a_wait
L_a_ln:
    v_lshlrev_b32 v7, 4, v1
    v_add_u32 v7, 0x98000, v7
    v_mov_b32 v224, s27
    v_mov_b32 v225, s27
    v_mov_b32 v226, s27
    v_mov_b32 v227, s27
    v_mov_b32 v228, s27
    v_mov_b32 v229, s27
    v_mov_b32 v230, s27
    v_mov_b32 v231, s27
    s_mov_b32 exec_lo, -1
    s_mov_b32 exec_hi, 0x00ffffff
L_poll_69:
    buffer_load_dwordx4 v[224:227], v7, s[12:15], 0 offen sc1
    buffer_load_dwordx4 v[228:231], v7, s[12:15], 0 offen offset:896 sc1
    s_waitcnt vmcnt(0)
    v_xor_b32 v9, s27, v225
    v_xor_b32 v10, s27, v227
    v_or_b32 v9, v9, v10
    v_xor_b32 v10, s27, v229
    v_or_b32 v9, v9, v10
    v_xor_b32 v10, s27, v231
    v_or_b32 v9, v9, v10
    v_cmp_ne_u32 vcc, 0, v9
    s_cbranch_vccz L_ok_70
    s_sub_u32 s30, s30, 1
    s_cbranch_scc0 L_poll_69
    s_mov_b32 s30, 0
L_ok_70:
    s_mov_b64 exec, -1
    s_mov_b32 s44, -1
    s_mov_b32 s45, 0x00ffffff
    v_lshlrev_b32 v232, 16, v224
    v_and_b32 v233, 0xffff0000, v224
    v_lshlrev_b32 v234, 16, v226
    v_and_b32 v235, 0xffff0000, v226
    v_lshlrev_b32 v236, 16, v228
    v_and_b32 v237, 0xffff0000, v228
    v_lshlrev_b32 v238, 16, v230
    v_and_b32 v239, 0xffff0000, v230
    v_readfirstlane_b32 s37, v232
    v_mov_b32 v8, 0
    v_mov_b32 v9, 0
    s_mov_b64 exec, s[44:45]
    v_subrev_f32 v10, s37, v232
    v_add_f32 v8, v8, v10
    v_fmac_f32 v9, v10, v10
    v_subrev_f32 v10, s37, v233
    v_add_f32 v8, v8, v10
    v_fmac_f32 v9, v10, v10
    v_subrev_f32 v10, s37, v234
    v_add_f32 v8, v8, v10
    v_fmac_f32 v9, v10, v10
    v_subrev_f32 v10, s37, v235
    v_add_f32 v8, v8, v10
    v_fmac_f32 v9, v10, v10
    v_subrev_f32 v10, s37, v236
    v_add_f32 v8, v8, v10
    v_fmac_f32 v9, v10, v10
    v_subrev_f32 v10, s37, v237
    v_add_f32 v8, v8, v10
    v_fmac_f32 v9, v10, v10
    v_subrev_f32 v10, s37, v238
    v_add_f32 v8, v8, v10
    v_fmac_f32 v9, v10, v10
    v_subrev_f32 v10, s37, v239
    v_add_f32 v8, v8, v10
    v_fmac_f32 v9, v10, v10
    s_mov_b64 exec, -1
    s_nop 1
    v_add_f32_dpp v8, v8, v8 row_ror:8 row_mask:0xf bank_mask:0xf
    v_add_f32_dpp v9, v9, v9 row_ror:8 row_mask:0xf bank_mask:0xf
    s_nop 0
    v_add_f32_dpp v8, v8, v8 row_ror:4 row_mask:0xf bank_mask:0xf
    v_add_f32_dpp v9, v9, v9 row_ror:4 row_mask:0xf bank_mask:0xf
    s_nop 0
    v_add_f32_dpp v8, v8, v8 row_ror:2 row_mask:0xf bank_mask:0xf
    v_add_f32_dpp v9, v9, v9 row_ror:2 row_mask:0xf bank_mask:0xf
    s_nop 0
    v_add_f32_dpp v8, v8, v8 row_ror:1 row_mask:0xf bank_mask:0xf
    v_add_f32_dpp v9, v9, v9 row_ror:1 row_mask:0xf bank_mask:0xf
    s_nop 0
    v_add_f32_dpp v8, v8, v8 row_bcast:15 row_mask:0xa bank_mask:0xf
    v_add_f32_dpp v9, v9, v9 row_bcast:15 row_mask:0xa bank_mask:0xf
    s_nop 0
    v_add_f32_dpp v8, v8, v8 row_bcast:31 row_mask:0xc bank_mask:0xf
    v_add_f32_dpp v9, v9, v9 row_bcast:31 row_mask:0xc bank_mask:0xf
    s_nop 0
    v_readlane_b32 s38, v8, 63
    v_readlane_b32 s39, v9, 63
    s_nop 1
    s_mov_b32 s40, 0x3b124925
    v_mov_b32 v10, s38
    v_mov_b32 v9, s39
    v_mul_f32 v10, s40, v10
    v_mul_f32 v9, s40, v9
    v_add_f32 v11, s37, v10
    v_fma_f32 v9, -v10, v10, v9
    v_cvt_pk_bf16_f32 v11, v11, v11
    v_max_f32 v9, 0, v9
    v_and_b32 v11, 0xffff0000, v11
    v_cvt_pk_bf16_f32 v9, v9, v9
    v_and_b32 v9, 0xffff0000, v9
    v_add_f32 v9, 0x3727c5ac, v9
    v_sub_f32 v232, v232, v11
    v_sub_f32 v233, v233, v11
    v_sub_f32 v234, v234, v11
    v_sub_f32 v235, v235, v11
    v_cvt_pk_bf16_f32 v9, v9, v9
    v_and_b32 v9, 0xffff0000, v9
    v_sqrt_f32 v9, v9
    v_sub_f32 v236, v236, v11
    v_sub_f32 v237, v237, v11
    v_sub_f32 v238, v238, v11
    v_sub_f32 v239, v239, v11
    v_cvt_pk_bf16_f32 v9, v9, v9
    v_and_b32 v9, 0xffff0000, v9
    v_rcp_f32 v3, v9
    v_cvt_pk_bf16_f32 v224, v232, v233
    v_cvt_pk_bf16_f32 v226, v234, v235
    v_cvt_pk_bf16_f32 v228, v236, v237
    v_cvt_pk_bf16_f32 v230, v238, v239
    v_lshlrev_b32 v232, 16, v224
    v_and_b32 v233, 0xffff0000, v224
    v_lshlrev_b32 v234, 16, v226
    v_and_b32 v235, 0xffff0000, v226
    v_lshlrev_b32 v236, 16, v228
    v_and_b32 v237, 0xffff0000, v228
    v_lshlrev_b32 v238, 16, v230
    v_and_b32 v239, 0xffff0000, v230
    v_mul_f32 v240, v232, v3
    v_mul_f32 v241, v233, v3
    v_mul_f32 v242, v234, v3
    v_mul_f32 v243, v235, v3
    v_mul_f32 v244, v236, v3
    v_mul_f32 v245, v237, v3
    v_mul_f32 v246, v238, v3
    v_mul_f32 v247, v239, v3
    v_fma_f32 v232, -v240, v9, v232
    v_fma_f32 v233, -v241, v9, v233
    v_fma_f32 v234, -v242, v9, v234
    v_fma_f32 v235, -v243, v9, v235
    v_fma_f32 v236, -v244, v9, v236
    v_fma_f32 v237, -v245, v9, v237
    v_fma_f32 v238, -v246, v9, v238
    v_fma_f32 v239, -v247, v9, v239
    v_fma_f32 v232, v232, v3, v240
    v_fma_f32 v233, v233, v3, v241
    v_fma_f32 v234, v234, v3, v242
    v_fma_f32 v235, v235, v3, v243
    v_fma_f32 v236, v236, v3, v244
    v_fma_f32 v237, v237, v3, v245
    v_fma_f32 v238, v238, v3, v246
    v_fma_f32 v239, v239, v3, v247
    v_cvt_pk_bf16_f32 v224, v232, v233
    v_cvt_pk_bf16_f32 v226, v234, v235
    v_cvt_pk_bf16_f32 v228, v236, v237
    v_cvt_pk_bf16_f32 v230, v238, v239
    s_mov_b64 exec, s[44:45]
    ds_write_b16 v32, v224 offset:10752
    ds_write_b16_d16_hi v33, v224 offset:10752
    ds_write_b16 v34, v226 offset:10752
    ds_write_b16_d16_hi v35, v226 offset:10752
    ds_write_b16 v36, v228 offset:10752
    ds_write_b16_d16_hi v37, v228 offset:10752
    ds_write_b16 v38, v230 offset:10752
    ds_write_b16_d16_hi v39, v230 offset:10752
    s_mov_b64 exec, -1
L_a_wait:
    v_lshrrev_b32 v7, 3, v1
    v_lshlrev_b32 v7, 2, v7
    s_lshl_b32 s37, s24, 7
    v_add_u32 v7, s37, v7
    v_mov_b32 v88, 0
    v_mov_b32 v89, 0
    v_mov_b32 v90, 0
    v_mov_b32 v91, 0
    v_mov_b32 v92, 0
    v_mov_b32 v93, 0
    v_mov_b32 v94, 0
    v_mov_b32 v95, 0
    s_waitcnt lgkmcnt(0)
    s_barrier
    ds_read_b32 v68, v7 offset:10752
    ds_read_b32 v69, v7 offset:10784
    ds_read_b32 v70, v7 offset:10816
    ds_read_b32 v71, v7 offset:10848
    v_lshlrev_b32 v10, 2, v1
    s_lshl_b32 s37, s24, 8
    v_add_u32 v11, s37, v10
    s_waitcnt lgkmcnt(0)
    v_dot2c_f32_bf16 v88, v160, v68
    v_dot2c_f32_bf16 v89, v164, v68
    v_dot2c_f32_bf16 v90, v161, v68
    v_dot2c_f32_bf16 v91, v165, v68
    v_dot2c_f32_bf16 v92, v162, v68
    v_dot2c_f32_bf16 v93, v166, v68
    v_dot2c_f32_bf16 v94, v163, v68
    v_dot2c_f32_bf16 v95, v167, v68
    v_dot2c_f32_bf16 v88, v168, v69
    v_dot2c_f32_bf16 v89, v172, v69
    v_dot2c_f32_bf16 v90, v169, v69
    v_dot2c_f32_bf16 v91, v173, v69
    v_dot2c_f32_bf16 v92, v170, v69
    v_dot2c_f32_bf16 v93, v174, v69
    v_dot2c_f32_bf16 v94, v171, v69
    v_dot2c_f32_bf16 v95, v175, v69
    v_dot2c_f32_bf16 v88, v176, v70
    v_dot2c_f32_bf16 v89, v180, v70
    v_dot2c_f32_bf16 v90, v177, v70
    v_dot2c_f32_bf16 v91, v181, v70
    v_dot2c_f32_bf16 v92, v178, v70
    v_dot2c_f32_bf16 v93, v182, v70
    v_dot2c_f32_bf16 v94, v179, v70
    v_dot2c_f32_bf16 v95, v183, v70
    v_dot2c_f32_bf16 v88, v184, v71
    v_dot2c_f32_bf16 v89, v188, v71
    v_dot2c_f32_bf16 v90, v185, v71
    v_dot2c_f32_bf16 v91, v189, v71
    v_dot2c_f32_bf16 v92, v186, v71
    v_dot2c_f32_bf16 v93, v190, v71
    v_dot2c_f32_bf16 v94, v187, v71
    v_dot2c_f32_bf16 v95, v191, v71
    s_nop 2
    v_permlane32_swap_b32 v88, v92
    v_permlane32_swap_b32 v89, v93
    v_permlane32_swap_b32 v90, v94
    v_permlane32_swap_b32 v91, v95
    s_nop 0
    v_pk_add_f32 v[88:89], v[88:89], v[92:93]
    v_pk_add_f32 v[90:91], v[90:91], v[94:95]
    s_nop 1
    v_permlane16_swap_b32 v88, v90
    v_permlane16_swap_b32 v89, v91
    s_nop 0
    v_pk_add_f32 v[88:89], v[88:89], v[90:91]
    s_nop 1
    v_add_f32_dpp v88, v88, v88 row_ror:8 row_mask:0xf bank_mask:0x3
    v_add_f32_dpp v88, v89, v89 row_ror:8 row_mask:0xf bank_mask:0xc
    s_nop 1
    ds_write_b32 v11, v88 offset:14336
    v_and_b32 v8, 7, v1
    v_lshlrev_b32 v8, 4, v8
    v_lshrrev_b32 v9, 3, v1
    v_lshlrev_b32 v9, 1, v9
    v_add_u32 v8, v8, v9
    s_lshr_b32 s37, s24, 2
    s_lshl_b32 s37, s37, 6
    v_mov_b32 v9, s37
    s_waitcnt lgkmcnt(0)
    s_barrier
    ds_read_b32 v88, v10 offset:14336
    ds_read_b32 v89, v10 offset:14592
    ds_read_b32 v90, v10 offset:14848
    ds_read_b32 v91, v10 offset:15104
    ds_read_b32 v92, v10 offset:15360
    ds_read_b32 v93, v10 offset:15616
    ds_read_b32 v94, v10 offset:15872
    ds_read_b32 v95, v10 offset:16128
    v_mov_b32 v226, 0
    v_mov_b32 v227, s27
    v_cmp_gt_u32 vcc, 224, v49
    s_waitcnt lgkmcnt(0)
    v_add_f32 v88, v88, v92
    v_add_f32 v89, v89, v93
    v_add_f32 v90, v90, v94
    v_add_f32 v91, v91, v95
    v_add_f32 v88, v88, v90
    v_add_f32 v89, v89, v91
    v_add_f32 v88, v88, v89
    v_cvt_pk_bf16_f32 v88, v88, v88
    v_and_b32 v88, 0xffff0000, v88
    v_add_f32 v88, v88, v66
    v_cvt_pk_bf16_f32 v88, v88, v88
    v_and_b32 v88, 0xffff0000, v88
    v_max_f32 v88, 0, v88
    v_mul_f32 v88, v88, v88
    v_cvt_pk_bf16_f32 v88, v88, v88
    ds_write_b16 v8, v88 offset:1280
    s_waitcnt lgkmcnt(0)
    ds_read_b128 v[72:75], v9 offset:1280
    ds_read_b128 v[76:79], v9 offset:1296
    ds_read_b128 v[80:83], v9 offset:1312
    ds_read_b128 v[84:87], v9 offset:1328
    v_mov_b32 v88, 0
    v_mov_b32 v89, 0
    v_mov_b32 v90, 0
    v_mov_b32 v91, 0
    v_mov_b32 v92, 0
    v_mov_b32 v93, 0
    v_mov_b32 v94, 0
    v_mov_b32 v95, 0
    s_waitcnt lgkmcnt(0)
    v_dot2c_f32_bf16 v88, v192, v72
    v_dot2c_f32_bf16 v92, v193, v72
    v_dot2c_f32_bf16 v89, v194, v73
    v_dot2c_f32_bf16 v93, v195, v73
    v_dot2c_f32_bf16 v90, v196, v74
    v_dot2c_f32_bf16 v94, v197, v74
    v_dot2c_f32_bf16 v91, v198, v75
    v_dot2c_f32_bf16 v95, v199, v75
    v_dot2c_f32_bf16 v88, v200, v76
    v_dot2c_f32_bf16 v92, v201, v76
    v_dot2c_f32_bf16 v89, v202, v77
    v_dot2c_f32_bf16 v93, v203, v77
    v_dot2c_f32_bf16 v90, v204, v78
    v_dot2c_f32_bf16 v94, v205, v78
    v_dot2c_f32_bf16 v91, v206, v79
    v_dot2c_f32_bf16 v95, v207, v79
    v_dot2c_f32_bf16 v88, v208, v80
    v_dot2c_f32_bf16 v92, v209, v80
    v_dot2c_f32_bf16 v89, v210, v81
    v_dot2c_f32_bf16 v93, v211, v81
    v_dot2c_f32_bf16 v90, v212, v82
    v_dot2c_f32_bf16 v94, v213, v82
    v_dot2c_f32_bf16 v91, v214, v83
    v_dot2c_f32_bf16 v95, v215, v83
    v_dot2c_f32_bf16 v88, v216, v84
    v_dot2c_f32_bf16 v92, v217, v84
    v_dot2c_f32_bf16 v89, v218, v85
    v_dot2c_f32_bf16 v93, v219, v85
    v_dot2c_f32_bf16 v90, v220, v86
    v_dot2c_f32_bf16 v94, v221, v86
    v_dot2c_f32_bf16 v91, v222, v87
    v_dot2c_f32_bf16 v95, v223, v87
    s_and_saveexec_b64 s[50:51], vcc
    s_nop 1
    v_add_f32 v88, v88, v89
    v_add_f32 v90, v90, v91
    v_add_f32 v92, v92, v93
    v_add_f32 v94, v94, v95
    v_add_f32 v224, v88, v90
    v_add_f32 v225, v92, v94
    s_cbranch_execz L_a_nost
    s_cmp_eq_u32 s57, 0
    s_cbranch_scc1 L_ls_71
    buffer_store_dwordx4 v[224:227], v48, s[12:15], 0 offen
    s_branch L_ls_72
L_ls_71:
    buffer_store_dwordx4 v[224:227], v48, s[12:15], 0 offen sc1
L_ls_72:
L_a_nost:
    s_mov_b64 exec, -1
    s_cmp_lg_u32 s24, 7
    s_cbranch_scc1 L_end
    v_lshlrev_b32 v7, 4, v1
    s_mul_i32 s37, s36, 7296
    s_add_u32 s37, s37, 0x9a000
    v_add_u32 v7, s37, v7
    s_movk_i32 s43, 0x1000
    v_and_b32 v8, 7, v1
    v_lshlrev_b32 v8, 1, v8
    v_lshrrev_b32 v11, 5, v1
    v_add_u32 v8, v8, v11
    v_lshlrev_b32 v11, 2, v8
    ds_read_b32 v232, v11 offset:1536
    v_lshlrev_b32 v233, 1, v8
    s_mov_b32 s16, s84
    s_mov_b32 s17, s85
    s_mov_b32 s18, 0x380
    s_mov_b32 s19, 0x20000
    s_mov_b32 s49, 127
L_sp_73:
    s_bitcmp1_b32 s49, 0
    s_cbranch_scc0 L_sk_76
    buffer_load_dwordx4 v[96:99], v7, s[12:15], 0 offen sc1
L_sk_76:
    s_bitcmp1_b32 s49, 1
    s_cbranch_scc0 L_sk_77
    buffer_load_dwordx4 v[100:103], v7, s[12:15], 0 offen offset:1024 sc1
L_sk_77:
    s_bitcmp1_b32 s49, 2
    s_cbranch_scc0 L_sk_78
    buffer_load_dwordx4 v[104:107], v7, s[12:15], 0 offen offset:2048 sc1
L_sk_78:
    s_bitcmp1_b32 s49, 3
    s_cbranch_scc0 L_sk_79
    buffer_load_dwordx4 v[108:111], v7, s[12:15], 0 offen offset:3072 sc1
L_sk_79:
    s_bitcmp1_b32 s49, 4
    s_cbranch_scc0 L_sk_80
    buffer_load_dwordx4 v[112:115], v7, s[12:15], s43 offen sc1
L_sk_80:
    s_bitcmp1_b32 s49, 5
    s_cbranch_scc0 L_sk_81
    buffer_load_dwordx4 v[116:119], v7, s[12:15], s43 offen offset:1024 sc1
L_sk_81:
    s_bitcmp1_b32 s49, 6
    s_cbranch_scc0 L_sk_82
    buffer_load_dwordx4 v[120:123], v7, s[12:15], s43 offen offset:2048 sc1
L_sk_82:
L_spchk_75:
    s_waitcnt vmcnt(0)
    s_bitcmp1_b32 s49, 0
    s_cbranch_scc0 L_sc_83
    v_cmp_ne_u32 vcc, s27, v99
    s_cbranch_vccnz L_sc_83
    s_bitset0_b32 s49, 0
L_sc_83:
    s_bitcmp1_b32 s49, 1
    s_cbranch_scc0 L_sc_84
    v_cmp_ne_u32 vcc, s27, v103
    s_cbranch_vccnz L_sc_84
    s_bitset0_b32 s49, 1
L_sc_84:
    s_bitcmp1_b32 s49, 2
    s_cbranch_scc0 L_sc_85
    v_cmp_ne_u32 vcc, s27, v107
    s_cbranch_vccnz L_sc_85
    s_bitset0_b32 s49, 2
L_sc_85:
    s_bitcmp1_b32 s49, 3
    s_cbranch_scc0 L_sc_86
    v_cmp_ne_u32 vcc, s27, v111
    s_cbranch_vccnz L_sc_86
    s_bitset0_b32 s49, 3
L_sc_86:
    s_bitcmp1_b32 s49, 4
    s_cbranch_scc0 L_sc_87
    v_cmp_ne_u32 vcc, s27, v115
    s_cbranch_vccnz L_sc_87
    s_bitset0_b32 s49, 4
L_sc_87:
    s_bitcmp1_b32 s49, 5
    s_cbranch_scc0 L_sc_88
    v_cmp_ne_u32 vcc, s27, v119
    s_cbranch_vccnz L_sc_88
    s_bitset0_b32 s49, 5
L_sc_88:
    s_bitcmp1_b32 s49, 6
    s_cbranch_scc0 L_sc_89
    v_cmp_ne_u32 vcc, s27, v123
    s_cbranch_vccnz L_sc_89
    s_bitset0_b32 s49, 6
L_sc_89:
    s_cmp_eq_u32 s49, 0
    s_cbranch_scc1 L_spok_74
    s_sub_u32 s30, s30, 1
    s_cbranch_scc0 L_sp_73
    s_mov_b32 s30, 0
L_spok_74:
    v_pk_add_f32 v[96:97], v[96:97], v[100:101]
    v_pk_add_f32 v[104:105], v[104:105], v[108:109]
    v_pk_add_f32 v[112:113], v[112:113], v[116:117]
    v_pk_add_f32 v[96:97], v[96:97], v[104:105]
    v_pk_add_f32 v[112:113], v[112:113], v[120:121]
    v_pk_add_f32 v[96:97], v[96:97], v[112:113]
    s_nop 1
    v_permlane32_swap_b32 v96, v97
    s_nop 0
    v_add_f32 v96, v96, v97
    v_mov_b32 v9, v96
    s_nop 1
    v_permlane16_swap_b32 v96, v9
    s_nop 0
    v_add_f32 v96, v96, v9
    s_nop 1
    v_add_f32_dpp v96, v96, v96 row_ror:8 row_mask:0xf bank_mask:0xf
    s_nop 0
    v_cvt_pk_bf16_f32 v96, v96, v96
    v_and_b32 v96, 0xffff0000, v96
    v_add_f32 v96, v96, v65
    v_cvt_pk_bf16_f32 v96, v96, v96
    v_and_b32 v96, 0xffff0000, v96
    s_waitcnt lgkmcnt(0)
    v_add_f32 v96, v96, v232
    v_cvt_pk_bf16_f32 v96, v96, v96
    s_lshl_b32 s37, s36, 5
    s_mov_b32 exec_lo, 0xff
    s_mov_b32 exec_hi, 0xff
    buffer_store_short v96, v233, s[16:19], s37 offen
    s_cmp_lg_u32 s36, 0
    s_cbranch_scc1 L_end
    s_add_u32 s38, s28, 1
    v_mov_b32 v8, s38
    v_mov_b32 v9, 0
    s_mov_b64 exec, 1
    buffer_store_dword v8, v9, s[12:15], 0 offen sc1
L_end:
L_exit:
    s_endpgm
.section .rodata,"a"
.p2align 6
.amdhsa_kernel sequential_preLN__mha_block_cached__dense_activation_squared_relu__decode_kernel
  .amdhsa_next_free_vgpr 256
  .amdhsa_next_free_sgpr 102
  .amdhsa_accum_offset 256
  .amdhsa_group_segment_fixed_size 0
  .amdhsa_kernarg_size 104
  .amdhsa_user_sgpr_count 2
  .amdhsa_user_sgpr_kernarg_segment_ptr 1
  .amdhsa_system_sgpr_workgroup_id_x 1
  .amdhsa_float_denorm_mode_32 3
.end_amdhsa_kernel
```
